```python
import torch

def _softmax(x, axis=-1):
    return torch.softmax(x, dim=axis)
def _gelu(x):
    return torch.nn.functional.gelu(x, approximate="tanh")
def _silu(x):
    return torch.nn.functional.silu(x)
def _sigmoid(x):
    return torch.sigmoid(x)
def _layernorm(x, axis=-1, eps=1e-5):
    m = x.mean(dim=axis, keepdim=True)
    v = x.var(dim=axis, keepdim=True, unbiased=False)
    return (x - m) / torch.sqrt(v + eps)
def _scatter_add(tgt, idx, src, axis=0):
    return tgt.clone().index_add_(axis, idx, src)
def _segment_sum(src, seg, n):
    out = torch.zeros((n,) + src.shape[1:], dtype=src.dtype)
    return out.index_add_(0, seg, src)
def _pad(x, pw):
    flat = tuple(v for pair in reversed(pw) for v in pair)
    return torch.nn.functional.pad(x, flat)

kernel_name = 'parallel_sum__sliding_block_cached__glu_gated_reglu__decode'

def setup_inputs():

    _w = (lambda a: (lambda t: t.to(torch.bfloat16) if t.is_floating_point() else t)(torch.as_tensor(a)))
    def _A_setup():
        B, Sq, D = 1, 1, 576
        Hq, Hkv, Sk, Dh = 32, 16, 32768, 128
        assert Hq % Hkv == 0, (Hq, Hkv)
        return {
            "x": _w((lambda *s: torch.randn(*s, dtype=torch.bfloat16) * 0.05)(B, Sq, D)),
            "k_cache": _w((lambda *s: torch.randn(*s, dtype=torch.bfloat16) * 1.6)(B, Hkv, Sk, Dh)),
            "v_cache": _w((lambda *s: torch.randn(*s, dtype=torch.bfloat16) * 0.8)(B, Hkv, Sk, Dh)),
            "wq": _w((lambda *s: torch.randn(*s, dtype=torch.bfloat16) * 1.6)(D, Hq * Dh) * (D ** -0.5)),
            "wo": _w((lambda *s: torch.randn(*s, dtype=torch.bfloat16) * 0.8)(Hq * Dh, D) * ((Hq * Dh) ** -0.5)),
        }
    _A_in = _A_setup()

    def _B_setup():
        B, S, D, F = 1, 1, 576, 4608
        return {
            "x": _w((lambda *s: torch.randn(*s, dtype=torch.bfloat16) * 0.05)(B, S, D)),
            "W_gate": _w((lambda *s: torch.randn(*s, dtype=torch.bfloat16) * 0.4)(D, F) * (2.0 / D) ** 0.5),
            "W_up": _w((lambda *s: torch.randn(*s, dtype=torch.bfloat16) * 0.4)(D, F) * (2.0 / D) ** 0.5),
            "W_down": _w((lambda *s: torch.randn(*s, dtype=torch.bfloat16) * 0.4)(F, D) * (1.0 / F) ** 0.5),
        }
    _B_in = _B_setup()

    return {
        "A_x": _A_in["x"],
        "A_k_cache": _A_in["k_cache"],
        "A_v_cache": _A_in["v_cache"],
        "A_wq": _A_in["wq"],
        "A_wo": _A_in["wo"],
        "B_x": _B_in["x"],
        "B_W_gate": _B_in["W_gate"],
        "B_W_up": _B_in["W_up"],
        "B_W_down": _B_in["W_down"],
    }

def reference(A_x, A_k_cache, A_v_cache, A_wq, A_wo, B_x, B_W_gate, B_W_up, B_W_down):
    def _A_ref(x, k_cache, v_cache, wq, wo):
        B, Sq, D = x.shape
        Hq, Dh = 32, 128
        Hkv, Sk = k_cache.shape[1], k_cache.shape[2]
        W = min(4096, max(256, Sk // 4))
        rep = Hq // Hkv
        q = (lambda x, *d: x.permute(*d))((x @ wq).reshape(B, Sq, Hq, Dh), 0, 2, 1, 3)
        k = (lambda x, n, axis: torch.repeat_interleave(x, n, dim=axis))(k_cache[:, :, Sk - W:, :], rep, axis=1)
        v = (lambda x, n, axis: torch.repeat_interleave(x, n, dim=axis))(v_cache[:, :, Sk - W:, :], rep, axis=1)
        scores = torch.einsum("bhqd,bhkd->bhqk", q, k) * (Dh ** -0.5)
        p = _softmax(scores, axis=-1)
        o = torch.einsum("bhqk,bhkd->bhqd", p, v)
        return (lambda x, *d: x.permute(*d))(o, 0, 2, 1, 3).reshape(B, Sq, Hq * Dh) @ wo

    def _B_ref(x, W_gate, W_up, W_down):
        gate = torch.einsum("bsd,df->bsf", x, W_gate)
        up = torch.einsum("bsd,df->bsf", x, W_up)
        gate = gate * (lambda x, dt: x.to(dt))(gate > 0, gate.dtype)
        h = gate * up
        return torch.einsum("bsf,fd->bsd", h, W_down)

    x = A_x
    xn = _layernorm(x, axis=-1)
    return x + _A_ref(xn, A_k_cache, A_v_cache, A_wq, A_wo) + _B_ref(xn, B_W_gate, B_W_up, B_W_down)
```

```asm
; @launch grid=(256,1,1) block=(512,1,1) lds=44608
.amdgcn_target "amdgcn-amd-amdhsa--gfx950"
.text
.globl parallel_sum__sliding_block_cached__glu_gated_reglu__decode_kernel
.p2align 8
.type parallel_sum__sliding_block_cached__glu_gated_reglu__decode_kernel,@function
parallel_sum__sliding_block_cached__glu_gated_reglu__decode_kernel:
  s_cmp_ge_u32 s2, 256
  s_cbranch_scc1 K_EXIT
  s_load_dwordx16 s[8:23], s[0:1], 0
  s_load_dwordx8 s[24:31], s[0:1], 64
  v_and_b32 v1, 63, v0
  v_lshrrev_b32 v2, 6, v0
  s_nop 1
  v_readfirstlane_b32 s3, v2
  s_waitcnt lgkmcnt(0)
  s_mov_b32 s80, s30
  s_mov_b32 s81, s31
  s_mov_b32 s82, 704512
  s_mov_b32 s83, 0x00020000
  s_mov_b32 s84, s28
  s_mov_b32 s85, s29
  s_mov_b32 s86, 256
  s_mov_b32 s87, 0x00020000
  s_lshr_b32 s4, s2, 4
  s_and_b32 s5, s2, 15
  s_mov_b32 s94, s3
  v_mov_b32 v57, 0
  s_or_b32 s7, s2, s3
  s_cmp_eq_u32 s7, 0
  s_cbranch_scc0 NOTAGW
  s_memrealtime s[92:93]
  s_waitcnt lgkmcnt(0)
  s_lshl_b32 s92, s92, 1
  s_or_b32 s92, s92, 1
  v_mov_b32 v4, s92
  v_lshlrev_b32 v3, 2, v1
  s_mov_b64 exec, 0xffffffff
  buffer_store_dword v4, v3, s[84:87], 0 offen sc0 sc1
  s_mov_b64 exec, -1
NOTAGW:
  s_cmp_ge_u32 s3, 4
  s_cbranch_scc1 G_ROLE
  s_cmp_eq_u32 s3, 0
  s_cbranch_scc0 A_NOX
  s_mov_b32 s32, s8
  s_mov_b32 s33, s9
  s_mov_b32 s34, 1152
  s_mov_b32 s35, 0x00020000
  v_lshlrev_b32 v3, 1, v1
  buffer_load_ushort v10, v3, s[32:35], 0 offen offset:0
  buffer_load_ushort v11, v3, s[32:35], 0 offen offset:128
  buffer_load_ushort v12, v3, s[32:35], 0 offen offset:256
  buffer_load_ushort v13, v3, s[32:35], 0 offen offset:384
  buffer_load_ushort v14, v3, s[32:35], 0 offen offset:512
  buffer_load_ushort v15, v3, s[32:35], 0 offen offset:640
  buffer_load_ushort v16, v3, s[32:35], 0 offen offset:768
  buffer_load_ushort v17, v3, s[32:35], 0 offen offset:896
  buffer_load_ushort v18, v3, s[32:35], 0 offen offset:1024
A_NOX:
  s_mul_i32 s32, s4, 0x800000
  s_lshl_b32 s33, s5, 16
  s_add_u32 s32, s32, s33
  s_add_u32 s32, s32, 0x700000
  s_add_u32 s36, s10, s32
  s_addc_u32 s37, s11, 0
  s_mov_b32 s38, 65536
  s_mov_b32 s39, 0x00020000
  s_add_u32 s40, s12, s32
  s_addc_u32 s41, s13, 0
  s_mov_b32 s42, 65536
  s_mov_b32 s43, 0x00020000
  v_lshlrev_b32 v3, 4, v0
  s_mul_i32 s33, s2, 5
  s_add_u32 s48, s33, 0
  s_and_b32 s48, s48, 15
  s_lshl_b32 s48, s48, 12
  s_add_u32 s49, s33, 1
  s_and_b32 s49, s49, 15
  s_lshl_b32 s49, s49, 12
  s_add_u32 s50, s33, 2
  s_and_b32 s50, s50, 15
  s_lshl_b32 s50, s50, 12
  s_add_u32 s51, s33, 3
  s_and_b32 s51, s51, 15
  s_lshl_b32 s51, s51, 12
  s_add_u32 s52, s33, 4
  s_and_b32 s52, s52, 15
  s_lshl_b32 s52, s52, 12
  s_add_u32 s53, s33, 5
  s_and_b32 s53, s53, 15
  s_lshl_b32 s53, s53, 12
  s_add_u32 s54, s33, 6
  s_and_b32 s54, s54, 15
  s_lshl_b32 s54, s54, 12
  s_add_u32 s55, s33, 7
  s_and_b32 s55, s55, 15
  s_lshl_b32 s55, s55, 12
  s_add_u32 s56, s33, 8
  s_and_b32 s56, s56, 15
  s_lshl_b32 s56, s56, 12
  s_add_u32 s57, s33, 9
  s_and_b32 s57, s57, 15
  s_lshl_b32 s57, s57, 12
  s_add_u32 s58, s33, 10
  s_and_b32 s58, s58, 15
  s_lshl_b32 s58, s58, 12
  s_add_u32 s59, s33, 11
  s_and_b32 s59, s59, 15
  s_lshl_b32 s59, s59, 12
  s_add_u32 s60, s33, 12
  s_and_b32 s60, s60, 15
  s_lshl_b32 s60, s60, 12
  s_add_u32 s61, s33, 13
  s_and_b32 s61, s61, 15
  s_lshl_b32 s61, s61, 12
  s_add_u32 s62, s33, 14
  s_and_b32 s62, s62, 15
  s_lshl_b32 s62, s62, 12
  s_add_u32 s63, s33, 15
  s_and_b32 s63, s63, 15
  s_lshl_b32 s63, s63, 12
  buffer_load_dwordx4 v[64:67], v3, s[36:39], s48 offen nt
  buffer_load_dwordx4 v[68:71], v3, s[36:39], s49 offen nt
  s_barrier
  s_cmp_eq_u32 s3, 0
  s_cbranch_scc0 A_NOX2
  s_waitcnt vmcnt(2)
  v_lshlrev_b32 v4, 2, v1
  v_lshlrev_b32 v10, 16, v10
  ds_write_b32 v4, v10 offset:42304
  v_lshlrev_b32 v11, 16, v11
  ds_write_b32 v4, v11 offset:42560
  v_lshlrev_b32 v12, 16, v12
  ds_write_b32 v4, v12 offset:42816
  v_lshlrev_b32 v13, 16, v13
  ds_write_b32 v4, v13 offset:43072
  v_lshlrev_b32 v14, 16, v14
  ds_write_b32 v4, v14 offset:43328
  v_lshlrev_b32 v15, 16, v15
  ds_write_b32 v4, v15 offset:43584
  v_lshlrev_b32 v16, 16, v16
  ds_write_b32 v4, v16 offset:43840
  v_lshlrev_b32 v17, 16, v17
  ds_write_b32 v4, v17 offset:44096
  v_lshlrev_b32 v18, 16, v18
  ds_write_b32 v4, v18 offset:44352
  s_waitcnt lgkmcnt(0)
  v_mov_b32 v58, 18732
  v_mov_b32 v59, 1
  s_mov_b64 exec, 1
  ds_add_u32 v58, v59
  s_mov_b64 exec, -1
A_NOX2:
  s_waitcnt vmcnt(1)
  buffer_load_dwordx4 v[72:75], v3, s[36:39], s50 offen nt
  s_waitcnt vmcnt(1)
  buffer_load_dwordx4 v[76:79], v3, s[36:39], s51 offen nt
  s_waitcnt vmcnt(1)
  buffer_load_dwordx4 v[80:83], v3, s[36:39], s52 offen nt
  s_waitcnt vmcnt(1)
  buffer_load_dwordx4 v[84:87], v3, s[36:39], s53 offen nt
  s_waitcnt vmcnt(5)
  buffer_load_dwordx4 v[88:91], v3, s[36:39], s54 offen nt
  s_waitcnt vmcnt(5)
  buffer_load_dwordx4 v[92:95], v3, s[36:39], s55 offen nt
  s_waitcnt vmcnt(5)
  buffer_load_dwordx4 v[96:99], v3, s[36:39], s56 offen nt
  s_waitcnt vmcnt(5)
  buffer_load_dwordx4 v[100:103], v3, s[36:39], s57 offen nt
  s_waitcnt vmcnt(5)
  buffer_load_dwordx4 v[104:107], v3, s[36:39], s58 offen nt
  s_waitcnt vmcnt(5)
  buffer_load_dwordx4 v[108:111], v3, s[36:39], s59 offen nt
  s_waitcnt vmcnt(5)
  buffer_load_dwordx4 v[112:115], v3, s[36:39], s60 offen nt
  s_waitcnt vmcnt(5)
  buffer_load_dwordx4 v[116:119], v3, s[36:39], s61 offen nt
  s_waitcnt vmcnt(5)
  buffer_load_dwordx4 v[120:123], v3, s[36:39], s62 offen nt
  s_waitcnt vmcnt(5)
  buffer_load_dwordx4 v[124:127], v3, s[36:39], s63 offen nt
  s_waitcnt vmcnt(5)
  buffer_load_dwordx4 v[128:131], v3, s[40:43], s48 offen nt
  s_waitcnt vmcnt(5)
  buffer_load_dwordx4 v[132:135], v3, s[40:43], s49 offen nt
  s_waitcnt vmcnt(5)
  buffer_load_dwordx4 v[136:139], v3, s[40:43], s50 offen nt
  s_waitcnt vmcnt(5)
  buffer_load_dwordx4 v[140:143], v3, s[40:43], s51 offen nt
  s_waitcnt vmcnt(5)
  buffer_load_dwordx4 v[144:147], v3, s[40:43], s52 offen nt
  s_waitcnt vmcnt(5)
  buffer_load_dwordx4 v[148:151], v3, s[40:43], s53 offen nt
  v_mov_b32 v192, 0
  v_mov_b32 v193, 0
  v_mov_b32 v194, 0
  v_mov_b32 v195, 0
  v_mov_b32 v196, 0
  v_mov_b32 v197, 0
  v_mov_b32 v198, 0
  v_mov_b32 v199, 0
  v_mov_b32 v200, 0
  v_mov_b32 v201, 0
  v_mov_b32 v202, 0
  v_mov_b32 v203, 0
  v_mov_b32 v204, 0
  v_mov_b32 v205, 0
  v_mov_b32 v206, 0
  v_mov_b32 v207, 0
  v_mov_b32 v208, 0
  v_mov_b32 v209, 0
  v_mov_b32 v210, 0
  v_mov_b32 v211, 0
  v_mov_b32 v212, 0
  v_mov_b32 v213, 0
  v_mov_b32 v214, 0
  v_mov_b32 v215, 0
  v_mov_b32 v216, 0
  v_mov_b32 v217, 0
  v_mov_b32 v218, 0
  v_mov_b32 v219, 0
  v_mov_b32 v220, 0
  v_mov_b32 v221, 0
  v_mov_b32 v222, 0
  v_mov_b32 v223, 0
  v_mov_b32 v58, 18692
  s_mov_b32 s91, 0
LW_1:
  ds_read_b32 v59, v58
  s_waitcnt lgkmcnt(0)
  v_readfirstlane_b32 s90, v59
  s_nop 3
  s_cmp_ge_u32 s90, 1
  s_cbranch_scc1 LD_2
  s_add_u32 s91, s91, 1
  s_cmp_gt_u32 s91, 1000000
  s_cbranch_scc1 LD_2
  s_sleep 1
  s_branch LW_1
LD_2:
  v_and_b32 v4, 15, v1
  v_lshlrev_b32 v4, 5, v4
  ds_read_b128 v[8:11], v4 offset:17408
  ds_read_b128 v[12:15], v4 offset:17424
  ds_read_b128 v[16:19], v4 offset:17920
  ds_read_b128 v[20:23], v4 offset:17936
  s_waitcnt lgkmcnt(0)
  v_cvt_pk_bf16_f32 v32, v8, v9
  v_cvt_pk_bf16_f32 v36, v16, v17
  v_cvt_pk_bf16_f32 v33, v10, v11
  v_cvt_pk_bf16_f32 v37, v18, v19
  v_cvt_pk_bf16_f32 v34, v12, v13
  v_cvt_pk_bf16_f32 v38, v20, v21
  v_cvt_pk_bf16_f32 v35, v14, v15
  v_cvt_pk_bf16_f32 v39, v22, v23
  s_waitcnt vmcnt(21)
  v_dot2c_f32_bf16 v192, v64, v32
  v_dot2c_f32_bf16 v208, v64, v36
  v_dot2c_f32_bf16 v192, v65, v33
  v_dot2c_f32_bf16 v208, v65, v37
  v_dot2c_f32_bf16 v192, v66, v34
  v_dot2c_f32_bf16 v208, v66, v38
  v_dot2c_f32_bf16 v192, v67, v35
  v_dot2c_f32_bf16 v208, v67, v39
  s_waitcnt vmcnt(20)
  v_dot2c_f32_bf16 v193, v68, v32
  v_dot2c_f32_bf16 v209, v68, v36
  v_dot2c_f32_bf16 v193, v69, v33
  v_dot2c_f32_bf16 v209, v69, v37
  v_dot2c_f32_bf16 v193, v70, v34
  v_dot2c_f32_bf16 v209, v70, v38
  v_dot2c_f32_bf16 v193, v71, v35
  v_dot2c_f32_bf16 v209, v71, v39
  s_waitcnt vmcnt(19)
  v_dot2c_f32_bf16 v194, v72, v32
  v_dot2c_f32_bf16 v210, v72, v36
  v_dot2c_f32_bf16 v194, v73, v33
  v_dot2c_f32_bf16 v210, v73, v37
  v_dot2c_f32_bf16 v194, v74, v34
  v_dot2c_f32_bf16 v210, v74, v38
  v_dot2c_f32_bf16 v194, v75, v35
  v_dot2c_f32_bf16 v210, v75, v39
  s_waitcnt vmcnt(18)
  v_dot2c_f32_bf16 v195, v76, v32
  v_dot2c_f32_bf16 v211, v76, v36
  v_dot2c_f32_bf16 v195, v77, v33
  v_dot2c_f32_bf16 v211, v77, v37
  v_dot2c_f32_bf16 v195, v78, v34
  v_dot2c_f32_bf16 v211, v78, v38
  v_dot2c_f32_bf16 v195, v79, v35
  v_dot2c_f32_bf16 v211, v79, v39
  s_waitcnt vmcnt(17)
  v_dot2c_f32_bf16 v196, v80, v32
  v_dot2c_f32_bf16 v212, v80, v36
  v_dot2c_f32_bf16 v196, v81, v33
  v_dot2c_f32_bf16 v212, v81, v37
  v_dot2c_f32_bf16 v196, v82, v34
  v_dot2c_f32_bf16 v212, v82, v38
  v_dot2c_f32_bf16 v196, v83, v35
  v_dot2c_f32_bf16 v212, v83, v39
  s_waitcnt vmcnt(16)
  v_dot2c_f32_bf16 v197, v84, v32
  v_dot2c_f32_bf16 v213, v84, v36
  v_dot2c_f32_bf16 v197, v85, v33
  v_dot2c_f32_bf16 v213, v85, v37
  v_dot2c_f32_bf16 v197, v86, v34
  v_dot2c_f32_bf16 v213, v86, v38
  v_dot2c_f32_bf16 v197, v87, v35
  v_dot2c_f32_bf16 v213, v87, v39
  s_waitcnt vmcnt(15)
  v_dot2c_f32_bf16 v198, v88, v32
  v_dot2c_f32_bf16 v214, v88, v36
  v_dot2c_f32_bf16 v198, v89, v33
  v_dot2c_f32_bf16 v214, v89, v37
  v_dot2c_f32_bf16 v198, v90, v34
  v_dot2c_f32_bf16 v214, v90, v38
  v_dot2c_f32_bf16 v198, v91, v35
  v_dot2c_f32_bf16 v214, v91, v39
  s_waitcnt vmcnt(14)
  v_dot2c_f32_bf16 v199, v92, v32
  v_dot2c_f32_bf16 v215, v92, v36
  v_dot2c_f32_bf16 v199, v93, v33
  v_dot2c_f32_bf16 v215, v93, v37
  v_dot2c_f32_bf16 v199, v94, v34
  v_dot2c_f32_bf16 v215, v94, v38
  v_dot2c_f32_bf16 v199, v95, v35
  v_dot2c_f32_bf16 v215, v95, v39
  s_waitcnt vmcnt(13)
  v_dot2c_f32_bf16 v200, v96, v32
  v_dot2c_f32_bf16 v216, v96, v36
  v_dot2c_f32_bf16 v200, v97, v33
  v_dot2c_f32_bf16 v216, v97, v37
  v_dot2c_f32_bf16 v200, v98, v34
  v_dot2c_f32_bf16 v216, v98, v38
  v_dot2c_f32_bf16 v200, v99, v35
  v_dot2c_f32_bf16 v216, v99, v39
  s_waitcnt vmcnt(12)
  v_dot2c_f32_bf16 v201, v100, v32
  v_dot2c_f32_bf16 v217, v100, v36
  v_dot2c_f32_bf16 v201, v101, v33
  v_dot2c_f32_bf16 v217, v101, v37
  v_dot2c_f32_bf16 v201, v102, v34
  v_dot2c_f32_bf16 v217, v102, v38
  v_dot2c_f32_bf16 v201, v103, v35
  v_dot2c_f32_bf16 v217, v103, v39
  s_waitcnt vmcnt(11)
  v_dot2c_f32_bf16 v202, v104, v32
  v_dot2c_f32_bf16 v218, v104, v36
  v_dot2c_f32_bf16 v202, v105, v33
  v_dot2c_f32_bf16 v218, v105, v37
  v_dot2c_f32_bf16 v202, v106, v34
  v_dot2c_f32_bf16 v218, v106, v38
  v_dot2c_f32_bf16 v202, v107, v35
  v_dot2c_f32_bf16 v218, v107, v39
  s_waitcnt vmcnt(10)
  v_dot2c_f32_bf16 v203, v108, v32
  v_dot2c_f32_bf16 v219, v108, v36
  v_dot2c_f32_bf16 v203, v109, v33
  v_dot2c_f32_bf16 v219, v109, v37
  v_dot2c_f32_bf16 v203, v110, v34
  v_dot2c_f32_bf16 v219, v110, v38
  v_dot2c_f32_bf16 v203, v111, v35
  v_dot2c_f32_bf16 v219, v111, v39
  s_waitcnt vmcnt(9)
  v_dot2c_f32_bf16 v204, v112, v32
  v_dot2c_f32_bf16 v220, v112, v36
  v_dot2c_f32_bf16 v204, v113, v33
  v_dot2c_f32_bf16 v220, v113, v37
  v_dot2c_f32_bf16 v204, v114, v34
  v_dot2c_f32_bf16 v220, v114, v38
  v_dot2c_f32_bf16 v204, v115, v35
  v_dot2c_f32_bf16 v220, v115, v39
  s_waitcnt vmcnt(8)
  v_dot2c_f32_bf16 v205, v116, v32
  v_dot2c_f32_bf16 v221, v116, v36
  v_dot2c_f32_bf16 v205, v117, v33
  v_dot2c_f32_bf16 v221, v117, v37
  v_dot2c_f32_bf16 v205, v118, v34
  v_dot2c_f32_bf16 v221, v118, v38
  v_dot2c_f32_bf16 v205, v119, v35
  v_dot2c_f32_bf16 v221, v119, v39
  s_waitcnt vmcnt(7)
  v_dot2c_f32_bf16 v206, v120, v32
  v_dot2c_f32_bf16 v222, v120, v36
  v_dot2c_f32_bf16 v206, v121, v33
  v_dot2c_f32_bf16 v222, v121, v37
  v_dot2c_f32_bf16 v206, v122, v34
  v_dot2c_f32_bf16 v222, v122, v38
  v_dot2c_f32_bf16 v206, v123, v35
  v_dot2c_f32_bf16 v222, v123, v39
  s_waitcnt vmcnt(6)
  v_dot2c_f32_bf16 v207, v124, v32
  v_dot2c_f32_bf16 v223, v124, v36
  v_dot2c_f32_bf16 v207, v125, v33
  v_dot2c_f32_bf16 v223, v125, v37
  v_dot2c_f32_bf16 v207, v126, v34
  v_dot2c_f32_bf16 v223, v126, v38
  v_dot2c_f32_bf16 v207, v127, v35
  v_dot2c_f32_bf16 v223, v127, v39
  s_nop 3
  v_add_f32_dpp v64, v192, v192 row_ror:8 row_mask:0xf bank_mask:0x3
  v_add_f32_dpp v65, v193, v193 row_ror:8 row_mask:0xf bank_mask:0x3
  v_add_f32_dpp v66, v194, v194 row_ror:8 row_mask:0xf bank_mask:0x3
  v_add_f32_dpp v67, v195, v195 row_ror:8 row_mask:0xf bank_mask:0x3
  v_add_f32_dpp v68, v196, v196 row_ror:8 row_mask:0xf bank_mask:0x3
  v_add_f32_dpp v69, v197, v197 row_ror:8 row_mask:0xf bank_mask:0x3
  v_add_f32_dpp v70, v198, v198 row_ror:8 row_mask:0xf bank_mask:0x3
  v_add_f32_dpp v71, v199, v199 row_ror:8 row_mask:0xf bank_mask:0x3
  v_add_f32_dpp v72, v200, v200 row_ror:8 row_mask:0xf bank_mask:0x3
  v_add_f32_dpp v73, v201, v201 row_ror:8 row_mask:0xf bank_mask:0x3
  v_add_f32_dpp v74, v202, v202 row_ror:8 row_mask:0xf bank_mask:0x3
  v_add_f32_dpp v75, v203, v203 row_ror:8 row_mask:0xf bank_mask:0x3
  v_add_f32_dpp v76, v204, v204 row_ror:8 row_mask:0xf bank_mask:0x3
  v_add_f32_dpp v77, v205, v205 row_ror:8 row_mask:0xf bank_mask:0x3
  v_add_f32_dpp v78, v206, v206 row_ror:8 row_mask:0xf bank_mask:0x3
  v_add_f32_dpp v79, v207, v207 row_ror:8 row_mask:0xf bank_mask:0x3
  v_add_f32_dpp v64, v208, v208 row_ror:8 row_mask:0xf bank_mask:0xc
  v_add_f32_dpp v65, v209, v209 row_ror:8 row_mask:0xf bank_mask:0xc
  v_add_f32_dpp v66, v210, v210 row_ror:8 row_mask:0xf bank_mask:0xc
  v_add_f32_dpp v67, v211, v211 row_ror:8 row_mask:0xf bank_mask:0xc
  v_add_f32_dpp v68, v212, v212 row_ror:8 row_mask:0xf bank_mask:0xc
  v_add_f32_dpp v69, v213, v213 row_ror:8 row_mask:0xf bank_mask:0xc
  v_add_f32_dpp v70, v214, v214 row_ror:8 row_mask:0xf bank_mask:0xc
  v_add_f32_dpp v71, v215, v215 row_ror:8 row_mask:0xf bank_mask:0xc
  v_add_f32_dpp v72, v216, v216 row_ror:8 row_mask:0xf bank_mask:0xc
  v_add_f32_dpp v73, v217, v217 row_ror:8 row_mask:0xf bank_mask:0xc
  v_add_f32_dpp v74, v218, v218 row_ror:8 row_mask:0xf bank_mask:0xc
  v_add_f32_dpp v75, v219, v219 row_ror:8 row_mask:0xf bank_mask:0xc
  v_add_f32_dpp v76, v220, v220 row_ror:8 row_mask:0xf bank_mask:0xc
  v_add_f32_dpp v77, v221, v221 row_ror:8 row_mask:0xf bank_mask:0xc
  v_add_f32_dpp v78, v222, v222 row_ror:8 row_mask:0xf bank_mask:0xc
  v_add_f32_dpp v79, v223, v223 row_ror:8 row_mask:0xf bank_mask:0xc
  v_add_f32_dpp v80, v64, v64 row_shl:4 row_mask:0xf bank_mask:0x5
  v_add_f32_dpp v81, v66, v66 row_shl:4 row_mask:0xf bank_mask:0x5
  v_add_f32_dpp v82, v68, v68 row_shl:4 row_mask:0xf bank_mask:0x5
  v_add_f32_dpp v83, v70, v70 row_shl:4 row_mask:0xf bank_mask:0x5
  v_add_f32_dpp v84, v72, v72 row_shl:4 row_mask:0xf bank_mask:0x5
  v_add_f32_dpp v85, v74, v74 row_shl:4 row_mask:0xf bank_mask:0x5
  v_add_f32_dpp v86, v76, v76 row_shl:4 row_mask:0xf bank_mask:0x5
  v_add_f32_dpp v87, v78, v78 row_shl:4 row_mask:0xf bank_mask:0x5
  v_add_f32_dpp v80, v65, v65 row_shr:4 row_mask:0xf bank_mask:0xa
  v_add_f32_dpp v81, v67, v67 row_shr:4 row_mask:0xf bank_mask:0xa
  v_add_f32_dpp v82, v69, v69 row_shr:4 row_mask:0xf bank_mask:0xa
  v_add_f32_dpp v83, v71, v71 row_shr:4 row_mask:0xf bank_mask:0xa
  v_add_f32_dpp v84, v73, v73 row_shr:4 row_mask:0xf bank_mask:0xa
  v_add_f32_dpp v85, v75, v75 row_shr:4 row_mask:0xf bank_mask:0xa
  v_add_f32_dpp v86, v77, v77 row_shr:4 row_mask:0xf bank_mask:0xa
  v_add_f32_dpp v87, v79, v79 row_shr:4 row_mask:0xf bank_mask:0xa
  v_add_f32_dpp v80, v80, v80 quad_perm:[2,3,0,1] row_mask:0xf bank_mask:0xf
  v_add_f32_dpp v81, v81, v81 quad_perm:[2,3,0,1] row_mask:0xf bank_mask:0xf
  v_add_f32_dpp v82, v82, v82 quad_perm:[2,3,0,1] row_mask:0xf bank_mask:0xf
  v_add_f32_dpp v83, v83, v83 quad_perm:[2,3,0,1] row_mask:0xf bank_mask:0xf
  v_add_f32_dpp v84, v84, v84 quad_perm:[2,3,0,1] row_mask:0xf bank_mask:0xf
  v_add_f32_dpp v85, v85, v85 quad_perm:[2,3,0,1] row_mask:0xf bank_mask:0xf
  v_add_f32_dpp v86, v86, v86 quad_perm:[2,3,0,1] row_mask:0xf bank_mask:0xf
  v_add_f32_dpp v87, v87, v87 quad_perm:[2,3,0,1] row_mask:0xf bank_mask:0xf
  v_add_f32_dpp v80, v80, v80 quad_perm:[1,0,3,2] row_mask:0xf bank_mask:0xf
  v_add_f32_dpp v81, v81, v81 quad_perm:[1,0,3,2] row_mask:0xf bank_mask:0xf
  v_add_f32_dpp v82, v82, v82 quad_perm:[1,0,3,2] row_mask:0xf bank_mask:0xf
  v_add_f32_dpp v83, v83, v83 quad_perm:[1,0,3,2] row_mask:0xf bank_mask:0xf
  v_add_f32_dpp v84, v84, v84 quad_perm:[1,0,3,2] row_mask:0xf bank_mask:0xf
  v_add_f32_dpp v85, v85, v85 quad_perm:[1,0,3,2] row_mask:0xf bank_mask:0xf
  v_add_f32_dpp v86, v86, v86 quad_perm:[1,0,3,2] row_mask:0xf bank_mask:0xf
  v_add_f32_dpp v87, v87, v87 quad_perm:[1,0,3,2] row_mask:0xf bank_mask:0xf
  s_mov_b32 s33, 0x3db504f3
  s_mov_b32 s34, 0x3fb8aa3b
  v_cvt_pk_bf16_f32 v80, v80, v80
  v_lshlrev_b32 v80, 16, v80
  v_mul_f32 v80, s33, v80
  v_cvt_pk_bf16_f32 v80, v80, v80
  v_lshlrev_b32 v80, 16, v80
  v_mul_f32 v80, s34, v80
  v_cvt_pk_bf16_f32 v81, v81, v81
  v_lshlrev_b32 v81, 16, v81
  v_mul_f32 v81, s33, v81
  v_cvt_pk_bf16_f32 v81, v81, v81
  v_lshlrev_b32 v81, 16, v81
  v_mul_f32 v81, s34, v81
  v_cvt_pk_bf16_f32 v82, v82, v82
  v_lshlrev_b32 v82, 16, v82
  v_mul_f32 v82, s33, v82
  v_cvt_pk_bf16_f32 v82, v82, v82
  v_lshlrev_b32 v82, 16, v82
  v_mul_f32 v82, s34, v82
  v_cvt_pk_bf16_f32 v83, v83, v83
  v_lshlrev_b32 v83, 16, v83
  v_mul_f32 v83, s33, v83
  v_cvt_pk_bf16_f32 v83, v83, v83
  v_lshlrev_b32 v83, 16, v83
  v_mul_f32 v83, s34, v83
  v_cvt_pk_bf16_f32 v84, v84, v84
  v_lshlrev_b32 v84, 16, v84
  v_mul_f32 v84, s33, v84
  v_cvt_pk_bf16_f32 v84, v84, v84
  v_lshlrev_b32 v84, 16, v84
  v_mul_f32 v84, s34, v84
  v_cvt_pk_bf16_f32 v85, v85, v85
  v_lshlrev_b32 v85, 16, v85
  v_mul_f32 v85, s33, v85
  v_cvt_pk_bf16_f32 v85, v85, v85
  v_lshlrev_b32 v85, 16, v85
  v_mul_f32 v85, s34, v85
  v_cvt_pk_bf16_f32 v86, v86, v86
  v_lshlrev_b32 v86, 16, v86
  v_mul_f32 v86, s33, v86
  v_cvt_pk_bf16_f32 v86, v86, v86
  v_lshlrev_b32 v86, 16, v86
  v_mul_f32 v86, s34, v86
  v_cvt_pk_bf16_f32 v87, v87, v87
  v_lshlrev_b32 v87, 16, v87
  v_mul_f32 v87, s33, v87
  v_cvt_pk_bf16_f32 v87, v87, v87
  v_lshlrev_b32 v87, 16, v87
  v_mul_f32 v87, s34, v87
  v_max_f32 v8, v80, v81
  v_max_f32 v8, v8, v82
  v_max_f32 v8, v8, v83
  v_max_f32 v8, v8, v84
  v_max_f32 v8, v8, v85
  v_max_f32 v8, v8, v86
  v_max_f32 v8, v8, v87
  s_nop 1
  v_max_f32_dpp v8, v8, v8 row_half_mirror row_mask:0xf bank_mask:0xf
  s_nop 1
  v_readlane_b32 s64, v8, 0
  v_readlane_b32 s68, v8, 8
  v_readlane_b32 s65, v8, 16
  v_readlane_b32 s69, v8, 24
  v_readlane_b32 s66, v8, 32
  v_readlane_b32 s70, v8, 40
  v_readlane_b32 s67, v8, 48
  v_readlane_b32 s71, v8, 56
  s_nop 3
  v_mov_b32 v9, s64
  v_mov_b32 v10, s68
  v_max_f32 v9, s65, v9
  v_max_f32 v10, s69, v10
  v_max_f32 v9, s66, v9
  v_max_f32 v10, s70, v10
  v_max_f32 v9, s67, v9
  v_max_f32 v10, s71, v10
  v_and_b32 v4, 8, v1
  v_cmp_ne_u32 vcc, 0, v4
  s_nop 1
  v_cndmask_b32 v8, v9, v10, vcc
  v_sub_f32 v80, v80, v8
  v_exp_f32 v80, v80
  v_sub_f32 v81, v81, v8
  v_exp_f32 v81, v81
  v_sub_f32 v82, v82, v8
  v_exp_f32 v82, v82
  v_sub_f32 v83, v83, v8
  v_exp_f32 v83, v83
  v_sub_f32 v84, v84, v8
  v_exp_f32 v84, v84
  v_sub_f32 v85, v85, v8
  v_exp_f32 v85, v85
  v_sub_f32 v86, v86, v8
  v_exp_f32 v86, v86
  v_sub_f32 v87, v87, v8
  v_exp_f32 v87, v87
  s_nop 0
  v_add_f32 v11, v80, v81
  v_add_f32 v11, v11, v82
  v_add_f32 v11, v11, v83
  v_add_f32 v11, v11, v84
  v_add_f32 v11, v11, v85
  v_add_f32 v11, v11, v86
  v_add_f32 v11, v11, v87
  v_mov_b32_dpp v192, v80 row_newbcast:0 row_mask:0xf bank_mask:0xf
  v_mov_b32_dpp v193, v80 row_newbcast:8 row_mask:0xf bank_mask:0xf
  v_mov_b32_dpp v194, v80 row_newbcast:4 row_mask:0xf bank_mask:0xf
  v_mov_b32_dpp v195, v80 row_newbcast:12 row_mask:0xf bank_mask:0xf
  v_mov_b32_dpp v196, v81 row_newbcast:0 row_mask:0xf bank_mask:0xf
  v_mov_b32_dpp v197, v81 row_newbcast:8 row_mask:0xf bank_mask:0xf
  v_mov_b32_dpp v198, v81 row_newbcast:4 row_mask:0xf bank_mask:0xf
  v_mov_b32_dpp v199, v81 row_newbcast:12 row_mask:0xf bank_mask:0xf
  v_mov_b32_dpp v200, v82 row_newbcast:0 row_mask:0xf bank_mask:0xf
  v_mov_b32_dpp v201, v82 row_newbcast:8 row_mask:0xf bank_mask:0xf
  v_mov_b32_dpp v202, v82 row_newbcast:4 row_mask:0xf bank_mask:0xf
  v_mov_b32_dpp v203, v82 row_newbcast:12 row_mask:0xf bank_mask:0xf
  v_mov_b32_dpp v204, v83 row_newbcast:0 row_mask:0xf bank_mask:0xf
  v_mov_b32_dpp v205, v83 row_newbcast:8 row_mask:0xf bank_mask:0xf
  v_mov_b32_dpp v206, v83 row_newbcast:4 row_mask:0xf bank_mask:0xf
  v_mov_b32_dpp v207, v83 row_newbcast:12 row_mask:0xf bank_mask:0xf
  v_mov_b32_dpp v208, v84 row_newbcast:0 row_mask:0xf bank_mask:0xf
  v_mov_b32_dpp v209, v84 row_newbcast:8 row_mask:0xf bank_mask:0xf
  v_mov_b32_dpp v210, v84 row_newbcast:4 row_mask:0xf bank_mask:0xf
  v_mov_b32_dpp v211, v84 row_newbcast:12 row_mask:0xf bank_mask:0xf
  v_mov_b32_dpp v212, v85 row_newbcast:0 row_mask:0xf bank_mask:0xf
  v_mov_b32_dpp v213, v85 row_newbcast:8 row_mask:0xf bank_mask:0xf
  v_mov_b32_dpp v214, v85 row_newbcast:4 row_mask:0xf bank_mask:0xf
  v_mov_b32_dpp v215, v85 row_newbcast:12 row_mask:0xf bank_mask:0xf
  v_mov_b32_dpp v216, v86 row_newbcast:0 row_mask:0xf bank_mask:0xf
  v_mov_b32_dpp v217, v86 row_newbcast:8 row_mask:0xf bank_mask:0xf
  v_mov_b32_dpp v218, v86 row_newbcast:4 row_mask:0xf bank_mask:0xf
  v_mov_b32_dpp v219, v86 row_newbcast:12 row_mask:0xf bank_mask:0xf
  v_mov_b32_dpp v220, v87 row_newbcast:0 row_mask:0xf bank_mask:0xf
  v_mov_b32_dpp v221, v87 row_newbcast:8 row_mask:0xf bank_mask:0xf
  v_mov_b32_dpp v222, v87 row_newbcast:4 row_mask:0xf bank_mask:0xf
  v_mov_b32_dpp v223, v87 row_newbcast:12 row_mask:0xf bank_mask:0xf
  v_add_f32_dpp v11, v11, v11 row_half_mirror row_mask:0xf bank_mask:0xf
  s_nop 1
  v_readlane_b32 s64, v11, 0
  v_readlane_b32 s68, v11, 8
  v_readlane_b32 s65, v11, 16
  v_readlane_b32 s69, v11, 24
  v_readlane_b32 s66, v11, 32
  v_readlane_b32 s70, v11, 40
  v_readlane_b32 s67, v11, 48
  v_readlane_b32 s71, v11, 56
  s_nop 3
  v_mov_b32 v11, s64
  v_mov_b32 v12, s68
  v_add_f32 v11, s65, v11
  v_add_f32 v12, s69, v12
  v_add_f32 v11, s66, v11
  v_add_f32 v12, s70, v12
  v_add_f32 v11, s67, v11
  v_add_f32 v12, s71, v12
  buffer_load_dwordx4 v[152:155], v3, s[40:43], s54 offen nt
  s_waitcnt vmcnt(6)
  v_lshlrev_b32 v6, 16, v128
  v_and_b32 v7, 0xffff0000, v128
  v_pk_mul_f32 v[16:17], v[6:7], v[192:193] op_sel_hi:[1,0]
  v_pk_mul_f32 v[24:25], v[6:7], v[192:193] op_sel:[0,1] op_sel_hi:[1,1]
  v_lshlrev_b32 v6, 16, v129
  v_and_b32 v7, 0xffff0000, v129
  v_pk_mul_f32 v[18:19], v[6:7], v[192:193] op_sel_hi:[1,0]
  v_pk_mul_f32 v[26:27], v[6:7], v[192:193] op_sel:[0,1] op_sel_hi:[1,1]
  v_lshlrev_b32 v6, 16, v130
  v_and_b32 v7, 0xffff0000, v130
  v_pk_mul_f32 v[20:21], v[6:7], v[192:193] op_sel_hi:[1,0]
  v_pk_mul_f32 v[28:29], v[6:7], v[192:193] op_sel:[0,1] op_sel_hi:[1,1]
  v_lshlrev_b32 v6, 16, v131
  v_and_b32 v7, 0xffff0000, v131
  v_pk_mul_f32 v[22:23], v[6:7], v[192:193] op_sel_hi:[1,0]
  v_pk_mul_f32 v[30:31], v[6:7], v[192:193] op_sel:[0,1] op_sel_hi:[1,1]
  buffer_load_dwordx4 v[156:159], v3, s[40:43], s55 offen nt
  s_waitcnt vmcnt(6)
  v_lshlrev_b32 v6, 16, v132
  v_and_b32 v7, 0xffff0000, v132
  v_pk_fma_f32 v[16:17], v[6:7], v[194:195], v[16:17] op_sel_hi:[1,0,1]
  v_pk_fma_f32 v[24:25], v[6:7], v[194:195], v[24:25] op_sel:[0,1,0] op_sel_hi:[1,1,1]
  v_lshlrev_b32 v6, 16, v133
  v_and_b32 v7, 0xffff0000, v133
  v_pk_fma_f32 v[18:19], v[6:7], v[194:195], v[18:19] op_sel_hi:[1,0,1]
  v_pk_fma_f32 v[26:27], v[6:7], v[194:195], v[26:27] op_sel:[0,1,0] op_sel_hi:[1,1,1]
  v_lshlrev_b32 v6, 16, v134
  v_and_b32 v7, 0xffff0000, v134
  v_pk_fma_f32 v[20:21], v[6:7], v[194:195], v[20:21] op_sel_hi:[1,0,1]
  v_pk_fma_f32 v[28:29], v[6:7], v[194:195], v[28:29] op_sel:[0,1,0] op_sel_hi:[1,1,1]
  v_lshlrev_b32 v6, 16, v135
  v_and_b32 v7, 0xffff0000, v135
  v_pk_fma_f32 v[22:23], v[6:7], v[194:195], v[22:23] op_sel_hi:[1,0,1]
  v_pk_fma_f32 v[30:31], v[6:7], v[194:195], v[30:31] op_sel:[0,1,0] op_sel_hi:[1,1,1]
  buffer_load_dwordx4 v[160:163], v3, s[40:43], s56 offen nt
  s_waitcnt vmcnt(6)
  v_lshlrev_b32 v6, 16, v136
  v_and_b32 v7, 0xffff0000, v136
  v_pk_fma_f32 v[16:17], v[6:7], v[196:197], v[16:17] op_sel_hi:[1,0,1]
  v_pk_fma_f32 v[24:25], v[6:7], v[196:197], v[24:25] op_sel:[0,1,0] op_sel_hi:[1,1,1]
  v_lshlrev_b32 v6, 16, v137
  v_and_b32 v7, 0xffff0000, v137
  v_pk_fma_f32 v[18:19], v[6:7], v[196:197], v[18:19] op_sel_hi:[1,0,1]
  v_pk_fma_f32 v[26:27], v[6:7], v[196:197], v[26:27] op_sel:[0,1,0] op_sel_hi:[1,1,1]
  v_lshlrev_b32 v6, 16, v138
  v_and_b32 v7, 0xffff0000, v138
  v_pk_fma_f32 v[20:21], v[6:7], v[196:197], v[20:21] op_sel_hi:[1,0,1]
  v_pk_fma_f32 v[28:29], v[6:7], v[196:197], v[28:29] op_sel:[0,1,0] op_sel_hi:[1,1,1]
  v_lshlrev_b32 v6, 16, v139
  v_and_b32 v7, 0xffff0000, v139
  v_pk_fma_f32 v[22:23], v[6:7], v[196:197], v[22:23] op_sel_hi:[1,0,1]
  v_pk_fma_f32 v[30:31], v[6:7], v[196:197], v[30:31] op_sel:[0,1,0] op_sel_hi:[1,1,1]
  buffer_load_dwordx4 v[164:167], v3, s[40:43], s57 offen nt
  s_waitcnt vmcnt(6)
  v_lshlrev_b32 v6, 16, v140
  v_and_b32 v7, 0xffff0000, v140
  v_pk_fma_f32 v[16:17], v[6:7], v[198:199], v[16:17] op_sel_hi:[1,0,1]
  v_pk_fma_f32 v[24:25], v[6:7], v[198:199], v[24:25] op_sel:[0,1,0] op_sel_hi:[1,1,1]
  v_lshlrev_b32 v6, 16, v141
  v_and_b32 v7, 0xffff0000, v141
  v_pk_fma_f32 v[18:19], v[6:7], v[198:199], v[18:19] op_sel_hi:[1,0,1]
  v_pk_fma_f32 v[26:27], v[6:7], v[198:199], v[26:27] op_sel:[0,1,0] op_sel_hi:[1,1,1]
  v_lshlrev_b32 v6, 16, v142
  v_and_b32 v7, 0xffff0000, v142
  v_pk_fma_f32 v[20:21], v[6:7], v[198:199], v[20:21] op_sel_hi:[1,0,1]
  v_pk_fma_f32 v[28:29], v[6:7], v[198:199], v[28:29] op_sel:[0,1,0] op_sel_hi:[1,1,1]
  v_lshlrev_b32 v6, 16, v143
  v_and_b32 v7, 0xffff0000, v143
  v_pk_fma_f32 v[22:23], v[6:7], v[198:199], v[22:23] op_sel_hi:[1,0,1]
  v_pk_fma_f32 v[30:31], v[6:7], v[198:199], v[30:31] op_sel:[0,1,0] op_sel_hi:[1,1,1]
  buffer_load_dwordx4 v[168:171], v3, s[40:43], s58 offen nt
  s_waitcnt vmcnt(6)
  v_lshlrev_b32 v6, 16, v144
  v_and_b32 v7, 0xffff0000, v144
  v_pk_fma_f32 v[16:17], v[6:7], v[200:201], v[16:17] op_sel_hi:[1,0,1]
  v_pk_fma_f32 v[24:25], v[6:7], v[200:201], v[24:25] op_sel:[0,1,0] op_sel_hi:[1,1,1]
  v_lshlrev_b32 v6, 16, v145
  v_and_b32 v7, 0xffff0000, v145
  v_pk_fma_f32 v[18:19], v[6:7], v[200:201], v[18:19] op_sel_hi:[1,0,1]
  v_pk_fma_f32 v[26:27], v[6:7], v[200:201], v[26:27] op_sel:[0,1,0] op_sel_hi:[1,1,1]
  v_lshlrev_b32 v6, 16, v146
  v_and_b32 v7, 0xffff0000, v146
  v_pk_fma_f32 v[20:21], v[6:7], v[200:201], v[20:21] op_sel_hi:[1,0,1]
  v_pk_fma_f32 v[28:29], v[6:7], v[200:201], v[28:29] op_sel:[0,1,0] op_sel_hi:[1,1,1]
  v_lshlrev_b32 v6, 16, v147
  v_and_b32 v7, 0xffff0000, v147
  v_pk_fma_f32 v[22:23], v[6:7], v[200:201], v[22:23] op_sel_hi:[1,0,1]
  v_pk_fma_f32 v[30:31], v[6:7], v[200:201], v[30:31] op_sel:[0,1,0] op_sel_hi:[1,1,1]
  buffer_load_dwordx4 v[172:175], v3, s[40:43], s59 offen nt
  s_waitcnt vmcnt(6)
  v_lshlrev_b32 v6, 16, v148
  v_and_b32 v7, 0xffff0000, v148
  v_pk_fma_f32 v[16:17], v[6:7], v[202:203], v[16:17] op_sel_hi:[1,0,1]
  v_pk_fma_f32 v[24:25], v[6:7], v[202:203], v[24:25] op_sel:[0,1,0] op_sel_hi:[1,1,1]
  v_lshlrev_b32 v6, 16, v149
  v_and_b32 v7, 0xffff0000, v149
  v_pk_fma_f32 v[18:19], v[6:7], v[202:203], v[18:19] op_sel_hi:[1,0,1]
  v_pk_fma_f32 v[26:27], v[6:7], v[202:203], v[26:27] op_sel:[0,1,0] op_sel_hi:[1,1,1]
  v_lshlrev_b32 v6, 16, v150
  v_and_b32 v7, 0xffff0000, v150
  v_pk_fma_f32 v[20:21], v[6:7], v[202:203], v[20:21] op_sel_hi:[1,0,1]
  v_pk_fma_f32 v[28:29], v[6:7], v[202:203], v[28:29] op_sel:[0,1,0] op_sel_hi:[1,1,1]
  v_lshlrev_b32 v6, 16, v151
  v_and_b32 v7, 0xffff0000, v151
  v_pk_fma_f32 v[22:23], v[6:7], v[202:203], v[22:23] op_sel_hi:[1,0,1]
  v_pk_fma_f32 v[30:31], v[6:7], v[202:203], v[30:31] op_sel:[0,1,0] op_sel_hi:[1,1,1]
  buffer_load_dwordx4 v[176:179], v3, s[40:43], s60 offen nt
  s_waitcnt vmcnt(6)
  v_lshlrev_b32 v6, 16, v152
  v_and_b32 v7, 0xffff0000, v152
  v_pk_fma_f32 v[16:17], v[6:7], v[204:205], v[16:17] op_sel_hi:[1,0,1]
  v_pk_fma_f32 v[24:25], v[6:7], v[204:205], v[24:25] op_sel:[0,1,0] op_sel_hi:[1,1,1]
  v_lshlrev_b32 v6, 16, v153
  v_and_b32 v7, 0xffff0000, v153
  v_pk_fma_f32 v[18:19], v[6:7], v[204:205], v[18:19] op_sel_hi:[1,0,1]
  v_pk_fma_f32 v[26:27], v[6:7], v[204:205], v[26:27] op_sel:[0,1,0] op_sel_hi:[1,1,1]
  v_lshlrev_b32 v6, 16, v154
  v_and_b32 v7, 0xffff0000, v154
  v_pk_fma_f32 v[20:21], v[6:7], v[204:205], v[20:21] op_sel_hi:[1,0,1]
  v_pk_fma_f32 v[28:29], v[6:7], v[204:205], v[28:29] op_sel:[0,1,0] op_sel_hi:[1,1,1]
  v_lshlrev_b32 v6, 16, v155
  v_and_b32 v7, 0xffff0000, v155
  v_pk_fma_f32 v[22:23], v[6:7], v[204:205], v[22:23] op_sel_hi:[1,0,1]
  v_pk_fma_f32 v[30:31], v[6:7], v[204:205], v[30:31] op_sel:[0,1,0] op_sel_hi:[1,1,1]
  buffer_load_dwordx4 v[180:183], v3, s[40:43], s61 offen nt
  s_waitcnt vmcnt(6)
  v_lshlrev_b32 v6, 16, v156
  v_and_b32 v7, 0xffff0000, v156
  v_pk_fma_f32 v[16:17], v[6:7], v[206:207], v[16:17] op_sel_hi:[1,0,1]
  v_pk_fma_f32 v[24:25], v[6:7], v[206:207], v[24:25] op_sel:[0,1,0] op_sel_hi:[1,1,1]
  v_lshlrev_b32 v6, 16, v157
  v_and_b32 v7, 0xffff0000, v157
  v_pk_fma_f32 v[18:19], v[6:7], v[206:207], v[18:19] op_sel_hi:[1,0,1]
  v_pk_fma_f32 v[26:27], v[6:7], v[206:207], v[26:27] op_sel:[0,1,0] op_sel_hi:[1,1,1]
  v_lshlrev_b32 v6, 16, v158
  v_and_b32 v7, 0xffff0000, v158
  v_pk_fma_f32 v[20:21], v[6:7], v[206:207], v[20:21] op_sel_hi:[1,0,1]
  v_pk_fma_f32 v[28:29], v[6:7], v[206:207], v[28:29] op_sel:[0,1,0] op_sel_hi:[1,1,1]
  v_lshlrev_b32 v6, 16, v159
  v_and_b32 v7, 0xffff0000, v159
  v_pk_fma_f32 v[22:23], v[6:7], v[206:207], v[22:23] op_sel_hi:[1,0,1]
  v_pk_fma_f32 v[30:31], v[6:7], v[206:207], v[30:31] op_sel:[0,1,0] op_sel_hi:[1,1,1]
  buffer_load_dwordx4 v[184:187], v3, s[40:43], s62 offen nt
  s_waitcnt vmcnt(6)
  v_lshlrev_b32 v6, 16, v160
  v_and_b32 v7, 0xffff0000, v160
  v_pk_fma_f32 v[16:17], v[6:7], v[208:209], v[16:17] op_sel_hi:[1,0,1]
  v_pk_fma_f32 v[24:25], v[6:7], v[208:209], v[24:25] op_sel:[0,1,0] op_sel_hi:[1,1,1]
  v_lshlrev_b32 v6, 16, v161
  v_and_b32 v7, 0xffff0000, v161
  v_pk_fma_f32 v[18:19], v[6:7], v[208:209], v[18:19] op_sel_hi:[1,0,1]
  v_pk_fma_f32 v[26:27], v[6:7], v[208:209], v[26:27] op_sel:[0,1,0] op_sel_hi:[1,1,1]
  v_lshlrev_b32 v6, 16, v162
  v_and_b32 v7, 0xffff0000, v162
  v_pk_fma_f32 v[20:21], v[6:7], v[208:209], v[20:21] op_sel_hi:[1,0,1]
  v_pk_fma_f32 v[28:29], v[6:7], v[208:209], v[28:29] op_sel:[0,1,0] op_sel_hi:[1,1,1]
  v_lshlrev_b32 v6, 16, v163
  v_and_b32 v7, 0xffff0000, v163
  v_pk_fma_f32 v[22:23], v[6:7], v[208:209], v[22:23] op_sel_hi:[1,0,1]
  v_pk_fma_f32 v[30:31], v[6:7], v[208:209], v[30:31] op_sel:[0,1,0] op_sel_hi:[1,1,1]
  buffer_load_dwordx4 v[188:191], v3, s[40:43], s63 offen nt
  s_waitcnt lgkmcnt(0)
  v_mov_b32 v58, 18736
  v_mov_b32 v59, 1
  s_mov_b64 exec, 1
  ds_add_u32 v58, v59
  s_mov_b64 exec, -1
  s_waitcnt vmcnt(6)
  v_lshlrev_b32 v6, 16, v164
  v_and_b32 v7, 0xffff0000, v164
  v_pk_fma_f32 v[16:17], v[6:7], v[210:211], v[16:17] op_sel_hi:[1,0,1]
  v_pk_fma_f32 v[24:25], v[6:7], v[210:211], v[24:25] op_sel:[0,1,0] op_sel_hi:[1,1,1]
  v_lshlrev_b32 v6, 16, v165
  v_and_b32 v7, 0xffff0000, v165
  v_pk_fma_f32 v[18:19], v[6:7], v[210:211], v[18:19] op_sel_hi:[1,0,1]
  v_pk_fma_f32 v[26:27], v[6:7], v[210:211], v[26:27] op_sel:[0,1,0] op_sel_hi:[1,1,1]
  v_lshlrev_b32 v6, 16, v166
  v_and_b32 v7, 0xffff0000, v166
  v_pk_fma_f32 v[20:21], v[6:7], v[210:211], v[20:21] op_sel_hi:[1,0,1]
  v_pk_fma_f32 v[28:29], v[6:7], v[210:211], v[28:29] op_sel:[0,1,0] op_sel_hi:[1,1,1]
  v_lshlrev_b32 v6, 16, v167
  v_and_b32 v7, 0xffff0000, v167
  v_pk_fma_f32 v[22:23], v[6:7], v[210:211], v[22:23] op_sel_hi:[1,0,1]
  v_pk_fma_f32 v[30:31], v[6:7], v[210:211], v[30:31] op_sel:[0,1,0] op_sel_hi:[1,1,1]
  s_waitcnt vmcnt(5)
  v_lshlrev_b32 v6, 16, v168
  v_and_b32 v7, 0xffff0000, v168
  v_pk_fma_f32 v[16:17], v[6:7], v[212:213], v[16:17] op_sel_hi:[1,0,1]
  v_pk_fma_f32 v[24:25], v[6:7], v[212:213], v[24:25] op_sel:[0,1,0] op_sel_hi:[1,1,1]
  v_lshlrev_b32 v6, 16, v169
  v_and_b32 v7, 0xffff0000, v169
  v_pk_fma_f32 v[18:19], v[6:7], v[212:213], v[18:19] op_sel_hi:[1,0,1]
  v_pk_fma_f32 v[26:27], v[6:7], v[212:213], v[26:27] op_sel:[0,1,0] op_sel_hi:[1,1,1]
  v_lshlrev_b32 v6, 16, v170
  v_and_b32 v7, 0xffff0000, v170
  v_pk_fma_f32 v[20:21], v[6:7], v[212:213], v[20:21] op_sel_hi:[1,0,1]
  v_pk_fma_f32 v[28:29], v[6:7], v[212:213], v[28:29] op_sel:[0,1,0] op_sel_hi:[1,1,1]
  v_lshlrev_b32 v6, 16, v171
  v_and_b32 v7, 0xffff0000, v171
  v_pk_fma_f32 v[22:23], v[6:7], v[212:213], v[22:23] op_sel_hi:[1,0,1]
  v_pk_fma_f32 v[30:31], v[6:7], v[212:213], v[30:31] op_sel:[0,1,0] op_sel_hi:[1,1,1]
  s_waitcnt vmcnt(4)
  v_lshlrev_b32 v6, 16, v172
  v_and_b32 v7, 0xffff0000, v172
  v_pk_fma_f32 v[16:17], v[6:7], v[214:215], v[16:17] op_sel_hi:[1,0,1]
  v_pk_fma_f32 v[24:25], v[6:7], v[214:215], v[24:25] op_sel:[0,1,0] op_sel_hi:[1,1,1]
  v_lshlrev_b32 v6, 16, v173
  v_and_b32 v7, 0xffff0000, v173
  v_pk_fma_f32 v[18:19], v[6:7], v[214:215], v[18:19] op_sel_hi:[1,0,1]
  v_pk_fma_f32 v[26:27], v[6:7], v[214:215], v[26:27] op_sel:[0,1,0] op_sel_hi:[1,1,1]
  v_lshlrev_b32 v6, 16, v174
  v_and_b32 v7, 0xffff0000, v174
  v_pk_fma_f32 v[20:21], v[6:7], v[214:215], v[20:21] op_sel_hi:[1,0,1]
  v_pk_fma_f32 v[28:29], v[6:7], v[214:215], v[28:29] op_sel:[0,1,0] op_sel_hi:[1,1,1]
  v_lshlrev_b32 v6, 16, v175
  v_and_b32 v7, 0xffff0000, v175
  v_pk_fma_f32 v[22:23], v[6:7], v[214:215], v[22:23] op_sel_hi:[1,0,1]
  v_pk_fma_f32 v[30:31], v[6:7], v[214:215], v[30:31] op_sel:[0,1,0] op_sel_hi:[1,1,1]
  s_waitcnt vmcnt(3)
  v_lshlrev_b32 v6, 16, v176
  v_and_b32 v7, 0xffff0000, v176
  v_pk_fma_f32 v[16:17], v[6:7], v[216:217], v[16:17] op_sel_hi:[1,0,1]
  v_pk_fma_f32 v[24:25], v[6:7], v[216:217], v[24:25] op_sel:[0,1,0] op_sel_hi:[1,1,1]
  v_lshlrev_b32 v6, 16, v177
  v_and_b32 v7, 0xffff0000, v177
  v_pk_fma_f32 v[18:19], v[6:7], v[216:217], v[18:19] op_sel_hi:[1,0,1]
  v_pk_fma_f32 v[26:27], v[6:7], v[216:217], v[26:27] op_sel:[0,1,0] op_sel_hi:[1,1,1]
  v_lshlrev_b32 v6, 16, v178
  v_and_b32 v7, 0xffff0000, v178
  v_pk_fma_f32 v[20:21], v[6:7], v[216:217], v[20:21] op_sel_hi:[1,0,1]
  v_pk_fma_f32 v[28:29], v[6:7], v[216:217], v[28:29] op_sel:[0,1,0] op_sel_hi:[1,1,1]
  v_lshlrev_b32 v6, 16, v179
  v_and_b32 v7, 0xffff0000, v179
  v_pk_fma_f32 v[22:23], v[6:7], v[216:217], v[22:23] op_sel_hi:[1,0,1]
  v_pk_fma_f32 v[30:31], v[6:7], v[216:217], v[30:31] op_sel:[0,1,0] op_sel_hi:[1,1,1]
  s_waitcnt vmcnt(2)
  v_lshlrev_b32 v6, 16, v180
  v_and_b32 v7, 0xffff0000, v180
  v_pk_fma_f32 v[16:17], v[6:7], v[218:219], v[16:17] op_sel_hi:[1,0,1]
  v_pk_fma_f32 v[24:25], v[6:7], v[218:219], v[24:25] op_sel:[0,1,0] op_sel_hi:[1,1,1]
  v_lshlrev_b32 v6, 16, v181
  v_and_b32 v7, 0xffff0000, v181
  v_pk_fma_f32 v[18:19], v[6:7], v[218:219], v[18:19] op_sel_hi:[1,0,1]
  v_pk_fma_f32 v[26:27], v[6:7], v[218:219], v[26:27] op_sel:[0,1,0] op_sel_hi:[1,1,1]
  v_lshlrev_b32 v6, 16, v182
  v_and_b32 v7, 0xffff0000, v182
  v_pk_fma_f32 v[20:21], v[6:7], v[218:219], v[20:21] op_sel_hi:[1,0,1]
  v_pk_fma_f32 v[28:29], v[6:7], v[218:219], v[28:29] op_sel:[0,1,0] op_sel_hi:[1,1,1]
  v_lshlrev_b32 v6, 16, v183
  v_and_b32 v7, 0xffff0000, v183
  v_pk_fma_f32 v[22:23], v[6:7], v[218:219], v[22:23] op_sel_hi:[1,0,1]
  v_pk_fma_f32 v[30:31], v[6:7], v[218:219], v[30:31] op_sel:[0,1,0] op_sel_hi:[1,1,1]
  s_waitcnt vmcnt(1)
  v_lshlrev_b32 v6, 16, v184
  v_and_b32 v7, 0xffff0000, v184
  v_pk_fma_f32 v[16:17], v[6:7], v[220:221], v[16:17] op_sel_hi:[1,0,1]
  v_pk_fma_f32 v[24:25], v[6:7], v[220:221], v[24:25] op_sel:[0,1,0] op_sel_hi:[1,1,1]
  v_lshlrev_b32 v6, 16, v185
  v_and_b32 v7, 0xffff0000, v185
  v_pk_fma_f32 v[18:19], v[6:7], v[220:221], v[18:19] op_sel_hi:[1,0,1]
  v_pk_fma_f32 v[26:27], v[6:7], v[220:221], v[26:27] op_sel:[0,1,0] op_sel_hi:[1,1,1]
  v_lshlrev_b32 v6, 16, v186
  v_and_b32 v7, 0xffff0000, v186
  v_pk_fma_f32 v[20:21], v[6:7], v[220:221], v[20:21] op_sel_hi:[1,0,1]
  v_pk_fma_f32 v[28:29], v[6:7], v[220:221], v[28:29] op_sel:[0,1,0] op_sel_hi:[1,1,1]
  v_lshlrev_b32 v6, 16, v187
  v_and_b32 v7, 0xffff0000, v187
  v_pk_fma_f32 v[22:23], v[6:7], v[220:221], v[22:23] op_sel_hi:[1,0,1]
  v_pk_fma_f32 v[30:31], v[6:7], v[220:221], v[30:31] op_sel:[0,1,0] op_sel_hi:[1,1,1]
  s_waitcnt vmcnt(0)
  v_lshlrev_b32 v6, 16, v188
  v_and_b32 v7, 0xffff0000, v188
  v_pk_fma_f32 v[16:17], v[6:7], v[222:223], v[16:17] op_sel_hi:[1,0,1]
  v_pk_fma_f32 v[24:25], v[6:7], v[222:223], v[24:25] op_sel:[0,1,0] op_sel_hi:[1,1,1]
  v_lshlrev_b32 v6, 16, v189
  v_and_b32 v7, 0xffff0000, v189
  v_pk_fma_f32 v[18:19], v[6:7], v[222:223], v[18:19] op_sel_hi:[1,0,1]
  v_pk_fma_f32 v[26:27], v[6:7], v[222:223], v[26:27] op_sel:[0,1,0] op_sel_hi:[1,1,1]
  v_lshlrev_b32 v6, 16, v190
  v_and_b32 v7, 0xffff0000, v190
  v_pk_fma_f32 v[20:21], v[6:7], v[222:223], v[20:21] op_sel_hi:[1,0,1]
  v_pk_fma_f32 v[28:29], v[6:7], v[222:223], v[28:29] op_sel:[0,1,0] op_sel_hi:[1,1,1]
  v_lshlrev_b32 v6, 16, v191
  v_and_b32 v7, 0xffff0000, v191
  v_pk_fma_f32 v[22:23], v[6:7], v[222:223], v[22:23] op_sel_hi:[1,0,1]
  v_pk_fma_f32 v[30:31], v[6:7], v[222:223], v[30:31] op_sel:[0,1,0] op_sel_hi:[1,1,1]
  v_lshrrev_b32 v5, 4, v0
  v_lshlrev_b32 v6, 10, v5
  v_and_b32 v7, 15, v1
  v_lshl_add_u32 v6, v7, 5, v6
  ds_write_b128 v6, v[16:19] offset:18944
  ds_write_b128 v6, v[20:23] offset:18960
  ds_write_b128 v6, v[24:27] offset:19456
  ds_write_b128 v6, v[28:31] offset:19472
  s_mov_b64 exec, 1
  v_lshlrev_b32 v4, 4, v2
  v_mov_b32 v16, v9
  v_mov_b32 v17, v10
  v_mov_b32 v18, v11
  v_mov_b32 v19, v12
  ds_write_b128 v4, v[16:19] offset:35328
  s_mov_b64 exec, -1
  s_waitcnt lgkmcnt(0)
  v_mov_b32 v58, 18696
  v_mov_b32 v59, 1
  s_mov_b64 exec, 1
  ds_add_u32 v58, v59
  s_mov_b64 exec, -1
  v_mov_b32 v58, 18724
  s_mov_b32 s91, 0
LW_3:
  ds_read_b32 v59, v58
  s_waitcnt lgkmcnt(0)
  v_readfirstlane_b32 s90, v59
  s_nop 3
  s_cmp_ge_u32 s90, 1
  s_cbranch_scc1 LD_4
  s_add_u32 s91, s91, 1
  s_cmp_gt_u32 s91, 1000000
  s_cbranch_scc1 LD_4
  s_sleep 1
  s_branch LW_3
LD_4:
  s_mov_b32 s95, s90
  v_mov_b32 v58, 18728
  s_mov_b32 s91, 0
LW_5:
  ds_read_b32 v59, v58
  s_waitcnt lgkmcnt(0)
  v_readfirstlane_b32 s90, v59
  s_nop 3
  s_cmp_ge_u32 s90, 1
  s_cbranch_scc1 LD_6
  s_add_u32 s91, s91, 1
  s_cmp_gt_u32 s91, 1000000
  s_cbranch_scc1 LD_6
  s_sleep 1
  s_branch LW_5
LD_6:
  v_mov_b32 v58, 18696
  s_mov_b32 s91, 0
LW_7:
  ds_read_b32 v59, v58
  s_waitcnt lgkmcnt(0)
  v_readfirstlane_b32 s90, v59
  s_nop 3
  s_cmp_ge_u32 s90, 4
  s_cbranch_scc1 LD_8
  s_add_u32 s91, s91, 1
  s_cmp_gt_u32 s91, 1000000
  s_cbranch_scc1 LD_8
  s_sleep 1
  s_branch LW_7
LD_8:
  v_lshrrev_b32 v1, 7, v0
  v_and_b32 v2, 127, v0
  v_lshlrev_b32 v3, 2, v1
  ds_read_b32 v8, v3 offset:35328
  ds_read_b32 v12, v3 offset:35336
  ds_read_b32 v9, v3 offset:35344
  ds_read_b32 v13, v3 offset:35352
  ds_read_b32 v10, v3 offset:35360
  ds_read_b32 v14, v3 offset:35368
  ds_read_b32 v11, v3 offset:35376
  ds_read_b32 v15, v3 offset:35384
  v_lshlrev_b32 v4, 2, v2
  v_lshl_add_u32 v4, v1, 9, v4
  ds_read_b32 v64, v4 offset:18944
  ds_read_b32 v65, v4 offset:19968
  ds_read_b32 v66, v4 offset:20992
  ds_read_b32 v67, v4 offset:22016
  ds_read_b32 v68, v4 offset:23040
  ds_read_b32 v69, v4 offset:24064
  ds_read_b32 v70, v4 offset:25088
  ds_read_b32 v71, v4 offset:26112
  ds_read_b32 v72, v4 offset:27136
  ds_read_b32 v73, v4 offset:28160
  ds_read_b32 v74, v4 offset:29184
  ds_read_b32 v75, v4 offset:30208
  ds_read_b32 v76, v4 offset:31232
  ds_read_b32 v77, v4 offset:32256
  ds_read_b32 v78, v4 offset:33280
  ds_read_b32 v79, v4 offset:34304
  s_waitcnt lgkmcnt(0)
  v_max_f32 v5, v8, v9
  v_max_f32 v5, v5, v10
  v_max_f32 v5, v5, v11
  v_sub_f32 v8, v8, v5
  v_exp_f32 v8, v8
  v_sub_f32 v9, v9, v5
  v_exp_f32 v9, v9
  v_sub_f32 v10, v10, v5
  v_exp_f32 v10, v10
  v_sub_f32 v11, v11, v5
  v_exp_f32 v11, v11
  v_add_f32 v64, v64, v65
  v_add_f32 v64, v64, v66
  v_add_f32 v64, v64, v67
  v_add_f32 v68, v68, v69
  v_add_f32 v68, v68, v70
  v_add_f32 v68, v68, v71
  v_add_f32 v72, v72, v73
  v_add_f32 v72, v72, v74
  v_add_f32 v72, v72, v75
  v_add_f32 v76, v76, v77
  v_add_f32 v76, v76, v78
  v_add_f32 v76, v76, v79
  v_mul_f32 v6, v8, v12
  v_mul_f32 v20, v8, v64
  v_fmac_f32 v6, v9, v13
  v_fmac_f32 v20, v9, v68
  v_fmac_f32 v6, v10, v14
  v_fmac_f32 v20, v10, v72
  v_fmac_f32 v6, v11, v15
  v_fmac_f32 v20, v11, v76
  s_lshl_b32 s32, s4, 5
  s_add_u32 s32, s32, s5
  v_lshl_add_u32 v8, v1, 4, s32
  v_lshlrev_b32 v9, 10, v8
  v_lshl_add_u32 v9, v2, 3, v9
  v_mov_b32 v21, s95
  s_mov_b32 s32, 131072
  buffer_store_dwordx2 v[20:21], v9, s[80:83], s32 offen sc0 sc1
  v_cmp_eq_u32 vcc, 0, v2
  s_and_saveexec_b64 s[66:67], vcc
  s_cbranch_execz A_NOST
  v_lshlrev_b32 v9, 4, v8
  v_mov_b32 v24, v5
  v_mov_b32 v25, s95
  v_mov_b32 v26, v6
  v_mov_b32 v27, s95
  s_mov_b32 s32, 655360
  buffer_store_dwordx4 v[24:27], v9, s[80:83], s32 offen sc0 sc1
A_NOST:
  s_mov_b64 exec, -1
  s_branch K_END
G_ROLE:
  v_subrev_u32 v0, 256, v0
  v_subrev_u32 v2, 4, v2
  s_sub_u32 s3, s3, 4
  v_lshlrev_b32 v4, 2, v0
  v_and_b32 v4, 0x1fc, v4
  v_mov_b32 v6, 0
  ds_write_b32 v4, v6 offset:18432
  s_cmp_ge_u32 s2, 208
  s_cbranch_scc1 G_SKIP1
  s_and_b32 s46, s2, 31
  s_lshl_b32 s46, s46, 2
  v_mov_b32 v56, 0
  buffer_load_dword v56, v56, s[84:87], s46 offen sc0 sc1
  s_cmp_lt_u32 s2, 64
  s_cselect_b32 s36, s14, s20
  s_cselect_b32 s37, s15, s21
  s_mov_b32 s40, 9216
  s_cselect_b32 s40, 8192, s40
  s_cselect_b32 s41, 0, 64
  s_cmp_lt_u32 s2, 136
  s_cselect_b32 s36, s36, s22
  s_cselect_b32 s37, s37, s23
  s_cselect_b32 s41, s41, 136
  s_sub_u32 s41, s2, s41
  s_lshl_b32 s41, s41, 7
  s_mul_i32 s38, s40, 576
  s_mov_b32 s39, 0x00020000
  v_lshrrev_b32 v4, 3, v1
  v_lshl_add_u32 v4, v2, 3, v4
  v_mov_b32 v8, v4
  v_mul_lo_u32 v4, v4, s40
  v_and_b32 v5, 7, v1
  v_lshlrev_b32 v5, 4, v5
  v_add3_u32 v4, v4, v5, s41
  s_lshl_b32 s42, s40, 5
  s_mov_b32 s43, 0
  buffer_load_dwordx4 v[100:103], v4, s[36:39], s43 offen nt
  s_add_u32 s43, s43, s42
  buffer_load_dwordx4 v[104:107], v4, s[36:39], s43 offen nt
  s_add_u32 s43, s43, s42
  buffer_load_dwordx4 v[108:111], v4, s[36:39], s43 offen nt
  s_add_u32 s43, s43, s42
  buffer_load_dwordx4 v[112:115], v4, s[36:39], s43 offen nt
  s_add_u32 s43, s43, s42
  buffer_load_dwordx4 v[116:119], v4, s[36:39], s43 offen nt
  s_add_u32 s43, s43, s42
  buffer_load_dwordx4 v[120:123], v4, s[36:39], s43 offen nt
  s_add_u32 s43, s43, s42
  buffer_load_dwordx4 v[124:127], v4, s[36:39], s43 offen nt
  s_add_u32 s43, s43, s42
  buffer_load_dwordx4 v[128:131], v4, s[36:39], s43 offen nt
  s_add_u32 s43, s43, s42
  buffer_load_dwordx4 v[132:135], v4, s[36:39], s43 offen nt
  s_add_u32 s43, s43, s42
  buffer_load_dwordx4 v[136:139], v4, s[36:39], s43 offen nt
  s_add_u32 s43, s43, s42
  buffer_load_dwordx4 v[140:143], v4, s[36:39], s43 offen nt
  s_add_u32 s43, s43, s42
  buffer_load_dwordx4 v[144:147], v4, s[36:39], s43 offen nt
  s_add_u32 s43, s43, s42
  s_waitcnt lgkmcnt(0)
  s_barrier
  v_mov_b32 v58, 18732
  s_mov_b32 s91, 0
LW_9:
  ds_read_b32 v59, v58
  s_waitcnt lgkmcnt(0)
  v_readfirstlane_b32 s90, v59
  s_nop 3
  s_cmp_ge_u32 s90, 1
  s_cbranch_scc1 LD_10
  s_add_u32 s91, s91, 1
  s_cmp_gt_u32 s91, 1000000
  s_cbranch_scc1 LD_10
  s_sleep 1
  s_branch LW_9
LD_10:
  v_lshlrev_b32 v3, 2, v1
  ds_read_b32 v10, v3 offset:42304
  ds_read_b32 v11, v3 offset:42560
  ds_read_b32 v12, v3 offset:42816
  ds_read_b32 v13, v3 offset:43072
  ds_read_b32 v14, v3 offset:43328
  ds_read_b32 v15, v3 offset:43584
  ds_read_b32 v16, v3 offset:43840
  ds_read_b32 v17, v3 offset:44096
  ds_read_b32 v18, v3 offset:44352
  s_waitcnt lgkmcnt(0)
  v_add_f32 v20, v10, v11
  v_add_f32 v20, v20, v12
  v_add_f32 v20, v20, v13
  v_add_f32 v20, v20, v14
  v_add_f32 v20, v20, v15
  v_add_f32 v20, v20, v16
  v_add_f32 v20, v20, v17
  v_add_f32 v20, v20, v18
  s_nop 1
  v_add_f32_dpp v20, v20, v20 row_shr:1 row_mask:0xf bank_mask:0xf bound_ctrl:0
  s_nop 1
  v_add_f32_dpp v20, v20, v20 row_shr:2 row_mask:0xf bank_mask:0xf bound_ctrl:0
  s_nop 1
  v_add_f32_dpp v20, v20, v20 row_shr:4 row_mask:0xf bank_mask:0xf bound_ctrl:0
  s_nop 1
  v_add_f32_dpp v20, v20, v20 row_shr:8 row_mask:0xf bank_mask:0xf bound_ctrl:0
  s_nop 1
  v_add_f32_dpp v20, v20, v20 row_bcast:15 row_mask:0xa bank_mask:0xf
  s_nop 1
  v_add_f32_dpp v20, v20, v20 row_bcast:31 row_mask:0xc bank_mask:0xf
  s_nop 1
  v_readlane_b32 s44, v20, 63
  s_nop 3
  v_mov_b32 v21, s44
  v_mul_f32 v21, 0x3ae38e39, v21
  v_mov_b32 v22, v21
  v_cvt_pk_bf16_f32 v22, v22, v22
  v_lshlrev_b32 v22, 16, v22
  v_sub_f32 v23, v10, v21
  v_mul_f32 v20, v23, v23
  v_sub_f32 v23, v11, v21
  v_fmac_f32 v20, v23, v23
  v_sub_f32 v23, v12, v21
  v_fmac_f32 v20, v23, v23
  v_sub_f32 v23, v13, v21
  v_fmac_f32 v20, v23, v23
  v_sub_f32 v23, v14, v21
  v_fmac_f32 v20, v23, v23
  v_sub_f32 v23, v15, v21
  v_fmac_f32 v20, v23, v23
  v_sub_f32 v23, v16, v21
  v_fmac_f32 v20, v23, v23
  v_sub_f32 v23, v17, v21
  v_fmac_f32 v20, v23, v23
  v_sub_f32 v23, v18, v21
  v_fmac_f32 v20, v23, v23
  s_nop 1
  v_add_f32_dpp v20, v20, v20 row_shr:1 row_mask:0xf bank_mask:0xf bound_ctrl:0
  s_nop 1
  v_add_f32_dpp v20, v20, v20 row_shr:2 row_mask:0xf bank_mask:0xf bound_ctrl:0
  s_nop 1
  v_add_f32_dpp v20, v20, v20 row_shr:4 row_mask:0xf bank_mask:0xf bound_ctrl:0
  s_nop 1
  v_add_f32_dpp v20, v20, v20 row_shr:8 row_mask:0xf bank_mask:0xf bound_ctrl:0
  s_nop 1
  v_add_f32_dpp v20, v20, v20 row_bcast:15 row_mask:0xa bank_mask:0xf
  s_nop 1
  v_add_f32_dpp v20, v20, v20 row_bcast:31 row_mask:0xc bank_mask:0xf
  s_nop 1
  v_readlane_b32 s44, v20, 63
  s_nop 3
  v_mov_b32 v21, s44
  v_mul_f32 v21, 0x3ae38e39, v21
  v_cvt_pk_bf16_f32 v21, v21, v21
  v_lshlrev_b32 v21, 16, v21
  v_add_f32 v21, 0x3727c5ac, v21
  v_cvt_pk_bf16_f32 v21, v21, v21
  v_lshlrev_b32 v21, 16, v21
  v_sqrt_f32 v21, v21
  s_nop 0
  v_cvt_pk_bf16_f32 v21, v21, v21
  v_lshlrev_b32 v21, 16, v21
  v_rcp_f32 v24, v21
  s_nop 0
  v_mul_u32_u24 v6, 576, v2
  v_add_u32 v6, v6, v1
  v_lshlrev_b32 v6, 2, v6
  v_sub_f32 v23, v10, v22
  v_cvt_pk_bf16_f32 v23, v23, v23
  v_lshlrev_b32 v23, 16, v23
  v_mul_f32 v25, v23, v24
  v_fma_f32 v26, -v25, v21, v23
  v_fmac_f32 v25, v26, v24
  v_cvt_pk_bf16_f32 v25, v25, v25
  v_lshlrev_b32 v25, 16, v25
  ds_write_b32 v6, v25 offset:0
  v_sub_f32 v23, v11, v22
  v_cvt_pk_bf16_f32 v23, v23, v23
  v_lshlrev_b32 v23, 16, v23
  v_mul_f32 v25, v23, v24
  v_fma_f32 v26, -v25, v21, v23
  v_fmac_f32 v25, v26, v24
  v_cvt_pk_bf16_f32 v25, v25, v25
  v_lshlrev_b32 v25, 16, v25
  ds_write_b32 v6, v25 offset:256
  v_sub_f32 v23, v12, v22
  v_cvt_pk_bf16_f32 v23, v23, v23
  v_lshlrev_b32 v23, 16, v23
  v_mul_f32 v25, v23, v24
  v_fma_f32 v26, -v25, v21, v23
  v_fmac_f32 v25, v26, v24
  v_cvt_pk_bf16_f32 v25, v25, v25
  v_lshlrev_b32 v25, 16, v25
  ds_write_b32 v6, v25 offset:512
  v_sub_f32 v23, v13, v22
  v_cvt_pk_bf16_f32 v23, v23, v23
  v_lshlrev_b32 v23, 16, v23
  v_mul_f32 v25, v23, v24
  v_fma_f32 v26, -v25, v21, v23
  v_fmac_f32 v25, v26, v24
  v_cvt_pk_bf16_f32 v25, v25, v25
  v_lshlrev_b32 v25, 16, v25
  ds_write_b32 v6, v25 offset:768
  v_sub_f32 v23, v14, v22
  v_cvt_pk_bf16_f32 v23, v23, v23
  v_lshlrev_b32 v23, 16, v23
  v_mul_f32 v25, v23, v24
  v_fma_f32 v26, -v25, v21, v23
  v_fmac_f32 v25, v26, v24
  v_cvt_pk_bf16_f32 v25, v25, v25
  v_lshlrev_b32 v25, 16, v25
  ds_write_b32 v6, v25 offset:1024
  v_sub_f32 v23, v15, v22
  v_cvt_pk_bf16_f32 v23, v23, v23
  v_lshlrev_b32 v23, 16, v23
  v_mul_f32 v25, v23, v24
  v_fma_f32 v26, -v25, v21, v23
  v_fmac_f32 v25, v26, v24
  v_cvt_pk_bf16_f32 v25, v25, v25
  v_lshlrev_b32 v25, 16, v25
  ds_write_b32 v6, v25 offset:1280
  v_sub_f32 v23, v16, v22
  v_cvt_pk_bf16_f32 v23, v23, v23
  v_lshlrev_b32 v23, 16, v23
  v_mul_f32 v25, v23, v24
  v_fma_f32 v26, -v25, v21, v23
  v_fmac_f32 v25, v26, v24
  v_cvt_pk_bf16_f32 v25, v25, v25
  v_lshlrev_b32 v25, 16, v25
  ds_write_b32 v6, v25 offset:1536
  v_sub_f32 v23, v17, v22
  v_cvt_pk_bf16_f32 v23, v23, v23
  v_lshlrev_b32 v23, 16, v23
  v_mul_f32 v25, v23, v24
  v_fma_f32 v26, -v25, v21, v23
  v_fmac_f32 v25, v26, v24
  v_cvt_pk_bf16_f32 v25, v25, v25
  v_lshlrev_b32 v25, 16, v25
  ds_write_b32 v6, v25 offset:1792
  v_sub_f32 v23, v18, v22
  v_cvt_pk_bf16_f32 v23, v23, v23
  v_lshlrev_b32 v23, 16, v23
  v_mul_f32 v25, v23, v24
  v_fma_f32 v26, -v25, v21, v23
  v_fmac_f32 v25, v26, v24
  v_cvt_pk_bf16_f32 v25, v25, v25
  v_lshlrev_b32 v25, 16, v25
  ds_write_b32 v6, v25 offset:2048
  v_mul_u32_u24 v7, 576, v2
  v_add_u32 v7, v7, v8
  v_lshlrev_b32 v7, 2, v7
  s_waitcnt lgkmcnt(0)
  ds_read_b32 v10, v7 offset:0
  ds_read_b32 v11, v7 offset:128
  ds_read_b32 v12, v7 offset:256
  ds_read_b32 v13, v7 offset:384
  ds_read_b32 v14, v7 offset:512
  ds_read_b32 v15, v7 offset:640
  ds_read_b32 v16, v7 offset:768
  ds_read_b32 v17, v7 offset:896
  ds_read_b32 v18, v7 offset:1024
  ds_read_b32 v19, v7 offset:1152
  ds_read_b32 v20, v7 offset:1280
  ds_read_b32 v21, v7 offset:1408
  ds_read_b32 v22, v7 offset:1536
  ds_read_b32 v23, v7 offset:1664
  ds_read_b32 v24, v7 offset:1792
  ds_read_b32 v25, v7 offset:1920
  ds_read_b32 v26, v7 offset:2048
  ds_read_b32 v27, v7 offset:2176
  v_mov_b32 v30, 0
  v_mov_b32 v31, 0
  v_mov_b32 v32, 0
  v_mov_b32 v33, 0
  v_mov_b32 v34, 0
  v_mov_b32 v35, 0
  v_mov_b32 v36, 0
  v_mov_b32 v37, 0
  s_waitcnt vmcnt(11)
  buffer_load_dwordx4 v[148:151], v4, s[36:39], s43 offen nt
  s_add_u32 s43, s43, s42
  s_waitcnt vmcnt(11)
  buffer_load_dwordx4 v[152:155], v4, s[36:39], s43 offen nt
  s_add_u32 s43, s43, s42
  s_waitcnt vmcnt(11)
  buffer_load_dwordx4 v[156:159], v4, s[36:39], s43 offen nt
  s_add_u32 s43, s43, s42
  s_waitcnt vmcnt(11)
  buffer_load_dwordx4 v[160:163], v4, s[36:39], s43 offen nt
  s_add_u32 s43, s43, s42
  s_waitcnt vmcnt(11)
  buffer_load_dwordx4 v[164:167], v4, s[36:39], s43 offen nt
  s_add_u32 s43, s43, s42
  s_waitcnt vmcnt(11)
  buffer_load_dwordx4 v[168:171], v4, s[36:39], s43 offen nt
  s_add_u32 s43, s43, s42
  s_waitcnt lgkmcnt(0)
  s_waitcnt vmcnt(17)
  v_lshlrev_b32 v28, 16, v100
  v_and_b32 v29, 0xffff0000, v100
  v_fmac_f32 v30, v28, v10
  v_fmac_f32 v31, v29, v10
  v_lshlrev_b32 v28, 16, v101
  v_and_b32 v29, 0xffff0000, v101
  v_fmac_f32 v32, v28, v10
  v_fmac_f32 v33, v29, v10
  v_lshlrev_b32 v28, 16, v102
  v_and_b32 v29, 0xffff0000, v102
  v_fmac_f32 v34, v28, v10
  v_fmac_f32 v35, v29, v10
  v_lshlrev_b32 v28, 16, v103
  v_and_b32 v29, 0xffff0000, v103
  v_fmac_f32 v36, v28, v10
  v_fmac_f32 v37, v29, v10
  s_waitcnt vmcnt(16)
  v_lshlrev_b32 v28, 16, v104
  v_and_b32 v29, 0xffff0000, v104
  v_fmac_f32 v30, v28, v11
  v_fmac_f32 v31, v29, v11
  v_lshlrev_b32 v28, 16, v105
  v_and_b32 v29, 0xffff0000, v105
  v_fmac_f32 v32, v28, v11
  v_fmac_f32 v33, v29, v11
  v_lshlrev_b32 v28, 16, v106
  v_and_b32 v29, 0xffff0000, v106
  v_fmac_f32 v34, v28, v11
  v_fmac_f32 v35, v29, v11
  v_lshlrev_b32 v28, 16, v107
  v_and_b32 v29, 0xffff0000, v107
  v_fmac_f32 v36, v28, v11
  v_fmac_f32 v37, v29, v11
  s_waitcnt vmcnt(15)
  v_lshlrev_b32 v28, 16, v108
  v_and_b32 v29, 0xffff0000, v108
  v_fmac_f32 v30, v28, v12
  v_fmac_f32 v31, v29, v12
  v_lshlrev_b32 v28, 16, v109
  v_and_b32 v29, 0xffff0000, v109
  v_fmac_f32 v32, v28, v12
  v_fmac_f32 v33, v29, v12
  v_lshlrev_b32 v28, 16, v110
  v_and_b32 v29, 0xffff0000, v110
  v_fmac_f32 v34, v28, v12
  v_fmac_f32 v35, v29, v12
  v_lshlrev_b32 v28, 16, v111
  v_and_b32 v29, 0xffff0000, v111
  v_fmac_f32 v36, v28, v12
  v_fmac_f32 v37, v29, v12
  s_waitcnt vmcnt(14)
  v_lshlrev_b32 v28, 16, v112
  v_and_b32 v29, 0xffff0000, v112
  v_fmac_f32 v30, v28, v13
  v_fmac_f32 v31, v29, v13
  v_lshlrev_b32 v28, 16, v113
  v_and_b32 v29, 0xffff0000, v113
  v_fmac_f32 v32, v28, v13
  v_fmac_f32 v33, v29, v13
  v_lshlrev_b32 v28, 16, v114
  v_and_b32 v29, 0xffff0000, v114
  v_fmac_f32 v34, v28, v13
  v_fmac_f32 v35, v29, v13
  v_lshlrev_b32 v28, 16, v115
  v_and_b32 v29, 0xffff0000, v115
  v_fmac_f32 v36, v28, v13
  v_fmac_f32 v37, v29, v13
  s_waitcnt vmcnt(13)
  v_lshlrev_b32 v28, 16, v116
  v_and_b32 v29, 0xffff0000, v116
  v_fmac_f32 v30, v28, v14
  v_fmac_f32 v31, v29, v14
  v_lshlrev_b32 v28, 16, v117
  v_and_b32 v29, 0xffff0000, v117
  v_fmac_f32 v32, v28, v14
  v_fmac_f32 v33, v29, v14
  v_lshlrev_b32 v28, 16, v118
  v_and_b32 v29, 0xffff0000, v118
  v_fmac_f32 v34, v28, v14
  v_fmac_f32 v35, v29, v14
  v_lshlrev_b32 v28, 16, v119
  v_and_b32 v29, 0xffff0000, v119
  v_fmac_f32 v36, v28, v14
  v_fmac_f32 v37, v29, v14
  s_waitcnt vmcnt(12)
  v_lshlrev_b32 v28, 16, v120
  v_and_b32 v29, 0xffff0000, v120
  v_fmac_f32 v30, v28, v15
  v_fmac_f32 v31, v29, v15
  v_lshlrev_b32 v28, 16, v121
  v_and_b32 v29, 0xffff0000, v121
  v_fmac_f32 v32, v28, v15
  v_fmac_f32 v33, v29, v15
  v_lshlrev_b32 v28, 16, v122
  v_and_b32 v29, 0xffff0000, v122
  v_fmac_f32 v34, v28, v15
  v_fmac_f32 v35, v29, v15
  v_lshlrev_b32 v28, 16, v123
  v_and_b32 v29, 0xffff0000, v123
  v_fmac_f32 v36, v28, v15
  v_fmac_f32 v37, v29, v15
  s_waitcnt vmcnt(11)
  v_lshlrev_b32 v28, 16, v124
  v_and_b32 v29, 0xffff0000, v124
  v_fmac_f32 v30, v28, v16
  v_fmac_f32 v31, v29, v16
  v_lshlrev_b32 v28, 16, v125
  v_and_b32 v29, 0xffff0000, v125
  v_fmac_f32 v32, v28, v16
  v_fmac_f32 v33, v29, v16
  v_lshlrev_b32 v28, 16, v126
  v_and_b32 v29, 0xffff0000, v126
  v_fmac_f32 v34, v28, v16
  v_fmac_f32 v35, v29, v16
  v_lshlrev_b32 v28, 16, v127
  v_and_b32 v29, 0xffff0000, v127
  v_fmac_f32 v36, v28, v16
  v_fmac_f32 v37, v29, v16
  s_waitcnt vmcnt(10)
  v_lshlrev_b32 v28, 16, v128
  v_and_b32 v29, 0xffff0000, v128
  v_fmac_f32 v30, v28, v17
  v_fmac_f32 v31, v29, v17
  v_lshlrev_b32 v28, 16, v129
  v_and_b32 v29, 0xffff0000, v129
  v_fmac_f32 v32, v28, v17
  v_fmac_f32 v33, v29, v17
  v_lshlrev_b32 v28, 16, v130
  v_and_b32 v29, 0xffff0000, v130
  v_fmac_f32 v34, v28, v17
  v_fmac_f32 v35, v29, v17
  v_lshlrev_b32 v28, 16, v131
  v_and_b32 v29, 0xffff0000, v131
  v_fmac_f32 v36, v28, v17
  v_fmac_f32 v37, v29, v17
  s_waitcnt vmcnt(9)
  v_lshlrev_b32 v28, 16, v132
  v_and_b32 v29, 0xffff0000, v132
  v_fmac_f32 v30, v28, v18
  v_fmac_f32 v31, v29, v18
  v_lshlrev_b32 v28, 16, v133
  v_and_b32 v29, 0xffff0000, v133
  v_fmac_f32 v32, v28, v18
  v_fmac_f32 v33, v29, v18
  v_lshlrev_b32 v28, 16, v134
  v_and_b32 v29, 0xffff0000, v134
  v_fmac_f32 v34, v28, v18
  v_fmac_f32 v35, v29, v18
  v_lshlrev_b32 v28, 16, v135
  v_and_b32 v29, 0xffff0000, v135
  v_fmac_f32 v36, v28, v18
  v_fmac_f32 v37, v29, v18
  s_waitcnt vmcnt(8)
  v_lshlrev_b32 v28, 16, v136
  v_and_b32 v29, 0xffff0000, v136
  v_fmac_f32 v30, v28, v19
  v_fmac_f32 v31, v29, v19
  v_lshlrev_b32 v28, 16, v137
  v_and_b32 v29, 0xffff0000, v137
  v_fmac_f32 v32, v28, v19
  v_fmac_f32 v33, v29, v19
  v_lshlrev_b32 v28, 16, v138
  v_and_b32 v29, 0xffff0000, v138
  v_fmac_f32 v34, v28, v19
  v_fmac_f32 v35, v29, v19
  v_lshlrev_b32 v28, 16, v139
  v_and_b32 v29, 0xffff0000, v139
  v_fmac_f32 v36, v28, v19
  v_fmac_f32 v37, v29, v19
  s_waitcnt vmcnt(7)
  v_lshlrev_b32 v28, 16, v140
  v_and_b32 v29, 0xffff0000, v140
  v_fmac_f32 v30, v28, v20
  v_fmac_f32 v31, v29, v20
  v_lshlrev_b32 v28, 16, v141
  v_and_b32 v29, 0xffff0000, v141
  v_fmac_f32 v32, v28, v20
  v_fmac_f32 v33, v29, v20
  v_lshlrev_b32 v28, 16, v142
  v_and_b32 v29, 0xffff0000, v142
  v_fmac_f32 v34, v28, v20
  v_fmac_f32 v35, v29, v20
  v_lshlrev_b32 v28, 16, v143
  v_and_b32 v29, 0xffff0000, v143
  v_fmac_f32 v36, v28, v20
  v_fmac_f32 v37, v29, v20
  s_waitcnt vmcnt(6)
  v_lshlrev_b32 v28, 16, v144
  v_and_b32 v29, 0xffff0000, v144
  v_fmac_f32 v30, v28, v21
  v_fmac_f32 v31, v29, v21
  v_lshlrev_b32 v28, 16, v145
  v_and_b32 v29, 0xffff0000, v145
  v_fmac_f32 v32, v28, v21
  v_fmac_f32 v33, v29, v21
  v_lshlrev_b32 v28, 16, v146
  v_and_b32 v29, 0xffff0000, v146
  v_fmac_f32 v34, v28, v21
  v_fmac_f32 v35, v29, v21
  v_lshlrev_b32 v28, 16, v147
  v_and_b32 v29, 0xffff0000, v147
  v_fmac_f32 v36, v28, v21
  v_fmac_f32 v37, v29, v21
  s_waitcnt vmcnt(5)
  v_lshlrev_b32 v28, 16, v148
  v_and_b32 v29, 0xffff0000, v148
  v_fmac_f32 v30, v28, v22
  v_fmac_f32 v31, v29, v22
  v_lshlrev_b32 v28, 16, v149
  v_and_b32 v29, 0xffff0000, v149
  v_fmac_f32 v32, v28, v22
  v_fmac_f32 v33, v29, v22
  v_lshlrev_b32 v28, 16, v150
  v_and_b32 v29, 0xffff0000, v150
  v_fmac_f32 v34, v28, v22
  v_fmac_f32 v35, v29, v22
  v_lshlrev_b32 v28, 16, v151
  v_and_b32 v29, 0xffff0000, v151
  v_fmac_f32 v36, v28, v22
  v_fmac_f32 v37, v29, v22
  s_waitcnt vmcnt(4)
  v_lshlrev_b32 v28, 16, v152
  v_and_b32 v29, 0xffff0000, v152
  v_fmac_f32 v30, v28, v23
  v_fmac_f32 v31, v29, v23
  v_lshlrev_b32 v28, 16, v153
  v_and_b32 v29, 0xffff0000, v153
  v_fmac_f32 v32, v28, v23
  v_fmac_f32 v33, v29, v23
  v_lshlrev_b32 v28, 16, v154
  v_and_b32 v29, 0xffff0000, v154
  v_fmac_f32 v34, v28, v23
  v_fmac_f32 v35, v29, v23
  v_lshlrev_b32 v28, 16, v155
  v_and_b32 v29, 0xffff0000, v155
  v_fmac_f32 v36, v28, v23
  v_fmac_f32 v37, v29, v23
  s_waitcnt vmcnt(3)
  v_lshlrev_b32 v28, 16, v156
  v_and_b32 v29, 0xffff0000, v156
  v_fmac_f32 v30, v28, v24
  v_fmac_f32 v31, v29, v24
  v_lshlrev_b32 v28, 16, v157
  v_and_b32 v29, 0xffff0000, v157
  v_fmac_f32 v32, v28, v24
  v_fmac_f32 v33, v29, v24
  v_lshlrev_b32 v28, 16, v158
  v_and_b32 v29, 0xffff0000, v158
  v_fmac_f32 v34, v28, v24
  v_fmac_f32 v35, v29, v24
  v_lshlrev_b32 v28, 16, v159
  v_and_b32 v29, 0xffff0000, v159
  v_fmac_f32 v36, v28, v24
  v_fmac_f32 v37, v29, v24
  s_waitcnt vmcnt(2)
  v_lshlrev_b32 v28, 16, v160
  v_and_b32 v29, 0xffff0000, v160
  v_fmac_f32 v30, v28, v25
  v_fmac_f32 v31, v29, v25
  v_lshlrev_b32 v28, 16, v161
  v_and_b32 v29, 0xffff0000, v161
  v_fmac_f32 v32, v28, v25
  v_fmac_f32 v33, v29, v25
  v_lshlrev_b32 v28, 16, v162
  v_and_b32 v29, 0xffff0000, v162
  v_fmac_f32 v34, v28, v25
  v_fmac_f32 v35, v29, v25
  v_lshlrev_b32 v28, 16, v163
  v_and_b32 v29, 0xffff0000, v163
  v_fmac_f32 v36, v28, v25
  v_fmac_f32 v37, v29, v25
  s_waitcnt vmcnt(1)
  v_lshlrev_b32 v28, 16, v164
  v_and_b32 v29, 0xffff0000, v164
  v_fmac_f32 v30, v28, v26
  v_fmac_f32 v31, v29, v26
  v_lshlrev_b32 v28, 16, v165
  v_and_b32 v29, 0xffff0000, v165
  v_fmac_f32 v32, v28, v26
  v_fmac_f32 v33, v29, v26
  v_lshlrev_b32 v28, 16, v166
  v_and_b32 v29, 0xffff0000, v166
  v_fmac_f32 v34, v28, v26
  v_fmac_f32 v35, v29, v26
  v_lshlrev_b32 v28, 16, v167
  v_and_b32 v29, 0xffff0000, v167
  v_fmac_f32 v36, v28, v26
  v_fmac_f32 v37, v29, v26
  s_waitcnt vmcnt(0)
  v_lshlrev_b32 v28, 16, v168
  v_and_b32 v29, 0xffff0000, v168
  v_fmac_f32 v30, v28, v27
  v_fmac_f32 v31, v29, v27
  v_lshlrev_b32 v28, 16, v169
  v_and_b32 v29, 0xffff0000, v169
  v_fmac_f32 v32, v28, v27
  v_fmac_f32 v33, v29, v27
  v_lshlrev_b32 v28, 16, v170
  v_and_b32 v29, 0xffff0000, v170
  v_fmac_f32 v34, v28, v27
  v_fmac_f32 v35, v29, v27
  v_lshlrev_b32 v28, 16, v171
  v_and_b32 v29, 0xffff0000, v171
  v_fmac_f32 v36, v28, v27
  v_fmac_f32 v37, v29, v27
  v_lshlrev_b32 v6, 5, v0
  ds_write_b128 v6, v[30:33] offset:9216
  ds_write_b128 v6, v[34:37] offset:9232
  s_waitcnt lgkmcnt(0)
  v_mov_b32 v58, 18688
  v_mov_b32 v59, 1
  s_mov_b64 exec, 1
  ds_add_u32 v58, v59
  s_mov_b64 exec, -1
  s_cmp_eq_u32 s3, 0
  s_cbranch_scc0 G_AFTER1
  s_mov_b32 s91, 0
TG_11:
  v_readfirstlane_b32 s95, v56
  s_nop 3
  s_cmp_lg_u32 s95, 0
  s_cbranch_scc1 TD_12
  s_add_u32 s91, s91, 1
  s_cmp_gt_u32 s91, 20000
  s_cbranch_scc1 TD_12
  s_sleep 4
  s_and_b32 s46, s2, 31
  s_lshl_b32 s46, s46, 2
  v_mov_b32 v56, 0
  buffer_load_dword v56, v56, s[84:87], s46 offen sc0 sc1
  s_waitcnt vmcnt(0)
  s_branch TG_11
TD_12:
  v_mov_b32 v4, 18724
  v_mov_b32 v5, s95
  s_mov_b64 exec, 1
  ds_write_b32 v4, v5
  s_mov_b64 exec, -1
  v_mov_b32 v58, 18688
  s_mov_b32 s91, 0
LW_13:
  ds_read_b32 v59, v58
  s_waitcnt lgkmcnt(0)
  v_readfirstlane_b32 s90, v59
  s_nop 3
  s_cmp_ge_u32 s90, 4
  s_cbranch_scc1 LD_14
  s_add_u32 s91, s91, 1
  s_cmp_gt_u32 s91, 1000000
  s_cbranch_scc1 LD_14
  s_sleep 1
  s_branch LW_13
LD_14:
  v_lshlrev_b32 v6, 2, v1
  ds_read_b32 v100, v6 offset:9216
  ds_read_b32 v101, v6 offset:9472
  ds_read_b32 v102, v6 offset:9728
  ds_read_b32 v103, v6 offset:9984
  ds_read_b32 v104, v6 offset:10240
  ds_read_b32 v105, v6 offset:10496
  ds_read_b32 v106, v6 offset:10752
  ds_read_b32 v107, v6 offset:11008
  ds_read_b32 v108, v6 offset:11264
  ds_read_b32 v109, v6 offset:11520
  ds_read_b32 v110, v6 offset:11776
  ds_read_b32 v111, v6 offset:12032
  ds_read_b32 v112, v6 offset:12288
  ds_read_b32 v113, v6 offset:12544
  ds_read_b32 v114, v6 offset:12800
  ds_read_b32 v115, v6 offset:13056
  ds_read_b32 v116, v6 offset:13312
  ds_read_b32 v117, v6 offset:13568
  ds_read_b32 v118, v6 offset:13824
  ds_read_b32 v119, v6 offset:14080
  ds_read_b32 v120, v6 offset:14336
  ds_read_b32 v121, v6 offset:14592
  ds_read_b32 v122, v6 offset:14848
  ds_read_b32 v123, v6 offset:15104
  ds_read_b32 v124, v6 offset:15360
  ds_read_b32 v125, v6 offset:15616
  ds_read_b32 v126, v6 offset:15872
  ds_read_b32 v127, v6 offset:16128
  ds_read_b32 v128, v6 offset:16384
  ds_read_b32 v129, v6 offset:16640
  ds_read_b32 v130, v6 offset:16896
  ds_read_b32 v131, v6 offset:17152
  s_waitcnt lgkmcnt(0)
  v_add_f32 v100, v100, v116
  v_add_f32 v101, v101, v117
  v_add_f32 v102, v102, v118
  v_add_f32 v103, v103, v119
  v_add_f32 v104, v104, v120
  v_add_f32 v105, v105, v121
  v_add_f32 v106, v106, v122
  v_add_f32 v107, v107, v123
  v_add_f32 v108, v108, v124
  v_add_f32 v109, v109, v125
  v_add_f32 v110, v110, v126
  v_add_f32 v111, v111, v127
  v_add_f32 v112, v112, v128
  v_add_f32 v113, v113, v129
  v_add_f32 v114, v114, v130
  v_add_f32 v115, v115, v131
  v_add_f32 v100, v100, v108
  v_add_f32 v101, v101, v109
  v_add_f32 v102, v102, v110
  v_add_f32 v103, v103, v111
  v_add_f32 v104, v104, v112
  v_add_f32 v105, v105, v113
  v_add_f32 v106, v106, v114
  v_add_f32 v107, v107, v115
  v_add_f32 v100, v100, v104
  v_add_f32 v101, v101, v105
  v_add_f32 v102, v102, v106
  v_add_f32 v103, v103, v107
  v_add_f32 v100, v100, v102
  v_add_f32 v101, v101, v103
  v_add_f32 v100, v100, v101
  v_cvt_pk_bf16_f32 v100, v100, v100
  v_lshlrev_b32 v100, 16, v100
  s_lshl_b32 s43, s2, 9
  v_mov_b32 v101, s95
  v_lshlrev_b32 v6, 3, v1
  buffer_store_dwordx2 v[100:101], v6, s[80:83], s43 offen sc0 sc1
  s_branch G_AFTER1
G_SKIP1:
  s_cmp_eq_u32 s3, 0
  s_cbranch_scc0 G_SKIP1B
  s_and_b32 s46, s2, 31
  s_lshl_b32 s46, s46, 2
  v_mov_b32 v56, 0
  buffer_load_dword v56, v56, s[84:87], s46 offen sc0 sc1
  s_waitcnt lgkmcnt(0)
  s_barrier
  s_waitcnt vmcnt(0)
  s_mov_b32 s91, 0
TG_15:
  v_readfirstlane_b32 s95, v56
  s_nop 3
  s_cmp_lg_u32 s95, 0
  s_cbranch_scc1 TD_16
  s_add_u32 s91, s91, 1
  s_cmp_gt_u32 s91, 20000
  s_cbranch_scc1 TD_16
  s_sleep 4
  s_and_b32 s46, s2, 31
  s_lshl_b32 s46, s46, 2
  v_mov_b32 v56, 0
  buffer_load_dword v56, v56, s[84:87], s46 offen sc0 sc1
  s_waitcnt vmcnt(0)
  s_branch TG_15
TD_16:
  v_mov_b32 v4, 18724
  v_mov_b32 v5, s95
  s_mov_b64 exec, 1
  ds_write_b32 v4, v5
  s_mov_b64 exec, -1
  s_branch G_AFTER1
G_SKIP1B:
  s_waitcnt lgkmcnt(0)
  s_barrier
G_AFTER1:
  s_cmp_eq_u32 s3, 0
  s_cbranch_scc1 G_HAVETAG
  v_mov_b32 v58, 18724
  s_mov_b32 s91, 0
LW_17:
  ds_read_b32 v59, v58
  s_waitcnt lgkmcnt(0)
  v_readfirstlane_b32 s90, v59
  s_nop 3
  s_cmp_ge_u32 s90, 1
  s_cbranch_scc1 LD_18
  s_add_u32 s91, s91, 1
  s_cmp_gt_u32 s91, 1000000
  s_cbranch_scc1 LD_18
  s_sleep 1
  s_branch LW_17
LD_18:
  s_mov_b32 s95, s90
G_HAVETAG:
  s_cmp_eq_u32 s3, 1
  s_cbranch_scc0 G_NOQ
  s_mul_i32 s44, s4, 2304
  s_mul_i32 s45, s5, 144
  s_add_u32 s44, s44, s45
  s_add_u32 s44, s44, 663552
  v_lshlrev_b32 v4, 2, v1
  v_mov_b32 v5, 0
  s_mov_b32 exec_lo, 0xffffffff
  s_mov_b32 exec_hi, 0xf
  buffer_store_dword v5, v4, s[80:83], s44 offen sc0 sc1
  s_cmp_eq_u32 s5, 0
  s_cbranch_scc0 G_NOCZ
  s_lshl_b32 s44, s4, 8
  s_add_u32 s44, s44, 700416
  buffer_store_dword v5, v4, s[80:83], s44 offen sc0 sc1
G_NOCZ:
  s_mov_b64 exec, -1
  v_lshlrev_b32 v4, 5, v1
  s_lshl_b32 s44, s4, 11
  s_mov_b32 s91, 0
PL_19:
  buffer_load_dwordx4 v[8:11], v4, s[80:83], s44 offen sc0 sc1
  buffer_load_dwordx4 v[12:15], v4, s[80:83], s44 offen offset:16 sc0 sc1
  s_waitcnt vmcnt(0)
  v_cmp_ne_u32 vcc, s95, v9
  v_cmp_ne_u32 s[50:51], s95, v11
  s_or_b64 vcc, vcc, s[50:51]
  v_cmp_ne_u32 s[50:51], s95, v13
  s_or_b64 vcc, vcc, s[50:51]
  v_cmp_ne_u32 s[50:51], s95, v15
  s_or_b64 vcc, vcc, s[50:51]
  s_cbranch_scc0 PD_20
  s_add_u32 s91, s91, 1
  s_cmp_gt_u32 s91, 20000
  s_cbranch_scc1 PD_20
  s_sleep 2
  s_branch PL_19
PD_20:
  v_mov_b32 v9, v10
  v_mov_b32 v10, v12
  v_mov_b32 v11, v14
  v_lshlrev_b32 v4, 4, v1
  ds_write_b128 v4, v[8:11] offset:17408
  s_waitcnt lgkmcnt(0)
  v_mov_b32 v58, 18692
  v_mov_b32 v59, 1
  s_mov_b64 exec, 1
  ds_add_u32 v58, v59
  s_mov_b64 exec, -1
  s_waitcnt lgkmcnt(0)
  v_mov_b32 v58, 18728
  v_mov_b32 v59, 1
  s_mov_b64 exec, 1
  ds_add_u32 v58, v59
  s_mov_b64 exec, -1
G_NOQ:
  s_mul_i32 s44, s2, 20736
  s_add_u32 s36, s24, s44
  s_addc_u32 s37, s25, 0
  s_mov_b32 s38, 20736
  s_mov_b32 s39, 0x00020000
  s_mul_i32 s44, s2, 18432
  s_add_u32 s40, s16, s44
  s_addc_u32 s41, s17, 0
  s_mov_b32 s42, 18432
  s_mov_b32 s43, 0x00020000
  v_lshlrev_b32 v3, 4, v0
  v_cmp_gt_u32 vcc, 216, v0
  v_mov_b32 v4, 0x7fffffff
  s_nop 1
  v_cndmask_b32 v3, v4, v3, vcc
  s_mov_b32 s44, 59652324
  v_mul_hi_u32 v7, v0, s44
  v_lshlrev_b32 v7, 2, v7
  s_cmp_eq_u32 s3, 0
  s_cbranch_scc0 G_NOH
  s_mul_i32 s44, s2, 144
  s_add_u32 s44, s44, 32768
  s_add_u32 s45, s44, 36864
  v_lshlrev_b32 v5, 3, v1
  s_mov_b64 exec, 0x3ffff
  s_mov_b32 s91, 0
PL_21:
  buffer_load_dwordx2 v[8:9], v5, s[80:83], s44 offen sc0 sc1
  buffer_load_dwordx2 v[10:11], v5, s[80:83], s45 offen sc0 sc1
  s_waitcnt vmcnt(0)
  v_cmp_ne_u32 vcc, s95, v9
  v_cmp_ne_u32 s[50:51], s95, v11
  s_or_b64 vcc, vcc, s[50:51]
  s_cbranch_scc0 PD_22
  s_add_u32 s91, s91, 1
  s_cmp_gt_u32 s91, 20000
  s_cbranch_scc1 PD_22
  s_sleep 2
  s_branch PL_21
PD_22:
  s_mov_b64 exec, -1
  v_lshlrev_b32 v5, 2, v1
  v_mul_f32 v6, v8, v10
  v_cvt_pk_bf16_f32 v6, v6, v6
  v_lshlrev_b32 v6, 16, v6
  v_cmp_lt_f32 vcc, 0, v8
  s_nop 1
  v_cndmask_b32 v6, 0, v6, vcc
  v_cmp_gt_u32 vcc, 18, v1
  s_nop 1
  v_cndmask_b32 v6, 0, v6, vcc
  v_cmp_gt_u32 vcc, 32, v1
  s_and_saveexec_b64 s[50:51], vcc
  ds_write_b32 v5, v6 offset:18560
  s_mov_b64 exec, -1
  s_waitcnt lgkmcnt(0)
  v_mov_b32 v58, 18700
  v_mov_b32 v59, 1
  s_mov_b64 exec, 1
  ds_add_u32 v58, v59
  s_mov_b64 exec, -1
G_NOH:
  v_mov_b32 v58, 18736
  s_mov_b32 s91, 0
LW_23:
  ds_read_b32 v59, v58
  s_waitcnt lgkmcnt(0)
  v_readfirstlane_b32 s90, v59
  s_nop 3
  s_cmp_ge_u32 s90, 4
  s_cbranch_scc1 LD_24
  s_add_u32 s91, s91, 1
  s_cmp_gt_u32 s91, 1000000
  s_cbranch_scc1 LD_24
  s_sleep 1
  s_branch LW_23
LD_24:
  s_mov_b32 s44, 0
  buffer_load_dwordx4 v[100:103], v3, s[36:39], s44 offen nt
  s_mov_b32 s44, 3456
  buffer_load_dwordx4 v[104:107], v3, s[36:39], s44 offen nt
  s_mov_b32 s44, 6912
  buffer_load_dwordx4 v[108:111], v3, s[36:39], s44 offen nt
  s_mov_b32 s44, 10368
  buffer_load_dwordx4 v[112:115], v3, s[36:39], s44 offen nt
  s_mov_b32 s44, 13824
  buffer_load_dwordx4 v[116:119], v3, s[36:39], s44 offen nt
  s_mov_b32 s44, 17280
  buffer_load_dwordx4 v[120:123], v3, s[36:39], s44 offen nt
  s_mov_b32 s44, 0
  buffer_load_dwordx4 v[64:67], v3, s[40:43], s44 offen nt
  s_mov_b32 s44, 3456
  buffer_load_dwordx4 v[68:71], v3, s[40:43], s44 offen nt
  s_mov_b32 s44, 6912
  buffer_load_dwordx4 v[72:75], v3, s[40:43], s44 offen nt
  s_mov_b32 s44, 10368
  buffer_load_dwordx4 v[76:79], v3, s[40:43], s44 offen nt
  s_mov_b32 s44, 13824
  buffer_load_dwordx4 v[80:83], v3, s[40:43], s44 offen nt
  s_mov_b32 s44, 17280
  buffer_load_dwordx4 v[84:87], v3, s[40:43], s44 offen nt
  v_mov_b32 v58, 18700
  s_mov_b32 s91, 0
LW_25:
  ds_read_b32 v59, v58
  s_waitcnt lgkmcnt(0)
  v_readfirstlane_b32 s90, v59
  s_nop 3
  s_cmp_ge_u32 s90, 1
  s_cbranch_scc1 LD_26
  s_add_u32 s91, s91, 1
  s_cmp_gt_u32 s91, 1000000
  s_cbranch_scc1 LD_26
  s_sleep 1
  s_branch LW_25
LD_26:
  s_waitcnt vmcnt(6)
  ds_read_b32 v8, v7 offset:18560
  ds_read_b32 v9, v7 offset:18572
  ds_read_b32 v10, v7 offset:18584
  ds_read_b32 v11, v7 offset:18596
  ds_read_b32 v12, v7 offset:18608
  ds_read_b32 v13, v7 offset:18620
  s_waitcnt lgkmcnt(0)
  v_lshlrev_b32 v5, 16, v100
  v_and_b32 v6, 0xffff0000, v100
  v_mul_f32 v16, v5, v8
  v_mul_f32 v17, v6, v8
  v_lshlrev_b32 v5, 16, v101
  v_and_b32 v6, 0xffff0000, v101
  v_mul_f32 v18, v5, v8
  v_mul_f32 v19, v6, v8
  v_lshlrev_b32 v5, 16, v102
  v_and_b32 v6, 0xffff0000, v102
  v_mul_f32 v20, v5, v8
  v_mul_f32 v21, v6, v8
  v_lshlrev_b32 v5, 16, v103
  v_and_b32 v6, 0xffff0000, v103
  v_mul_f32 v22, v5, v8
  v_mul_f32 v23, v6, v8
  v_lshlrev_b32 v5, 16, v104
  v_and_b32 v6, 0xffff0000, v104
  v_fmac_f32 v16, v5, v9
  v_fmac_f32 v17, v6, v9
  v_lshlrev_b32 v5, 16, v105
  v_and_b32 v6, 0xffff0000, v105
  v_fmac_f32 v18, v5, v9
  v_fmac_f32 v19, v6, v9
  v_lshlrev_b32 v5, 16, v106
  v_and_b32 v6, 0xffff0000, v106
  v_fmac_f32 v20, v5, v9
  v_fmac_f32 v21, v6, v9
  v_lshlrev_b32 v5, 16, v107
  v_and_b32 v6, 0xffff0000, v107
  v_fmac_f32 v22, v5, v9
  v_fmac_f32 v23, v6, v9
  v_lshlrev_b32 v5, 16, v108
  v_and_b32 v6, 0xffff0000, v108
  v_fmac_f32 v16, v5, v10
  v_fmac_f32 v17, v6, v10
  v_lshlrev_b32 v5, 16, v109
  v_and_b32 v6, 0xffff0000, v109
  v_fmac_f32 v18, v5, v10
  v_fmac_f32 v19, v6, v10
  v_lshlrev_b32 v5, 16, v110
  v_and_b32 v6, 0xffff0000, v110
  v_fmac_f32 v20, v5, v10
  v_fmac_f32 v21, v6, v10
  v_lshlrev_b32 v5, 16, v111
  v_and_b32 v6, 0xffff0000, v111
  v_fmac_f32 v22, v5, v10
  v_fmac_f32 v23, v6, v10
  v_lshlrev_b32 v5, 16, v112
  v_and_b32 v6, 0xffff0000, v112
  v_fmac_f32 v16, v5, v11
  v_fmac_f32 v17, v6, v11
  v_lshlrev_b32 v5, 16, v113
  v_and_b32 v6, 0xffff0000, v113
  v_fmac_f32 v18, v5, v11
  v_fmac_f32 v19, v6, v11
  v_lshlrev_b32 v5, 16, v114
  v_and_b32 v6, 0xffff0000, v114
  v_fmac_f32 v20, v5, v11
  v_fmac_f32 v21, v6, v11
  v_lshlrev_b32 v5, 16, v115
  v_and_b32 v6, 0xffff0000, v115
  v_fmac_f32 v22, v5, v11
  v_fmac_f32 v23, v6, v11
  v_lshlrev_b32 v5, 16, v116
  v_and_b32 v6, 0xffff0000, v116
  v_fmac_f32 v16, v5, v12
  v_fmac_f32 v17, v6, v12
  v_lshlrev_b32 v5, 16, v117
  v_and_b32 v6, 0xffff0000, v117
  v_fmac_f32 v18, v5, v12
  v_fmac_f32 v19, v6, v12
  v_lshlrev_b32 v5, 16, v118
  v_and_b32 v6, 0xffff0000, v118
  v_fmac_f32 v20, v5, v12
  v_fmac_f32 v21, v6, v12
  v_lshlrev_b32 v5, 16, v119
  v_and_b32 v6, 0xffff0000, v119
  v_fmac_f32 v22, v5, v12
  v_fmac_f32 v23, v6, v12
  v_lshlrev_b32 v5, 16, v120
  v_and_b32 v6, 0xffff0000, v120
  v_fmac_f32 v16, v5, v13
  v_fmac_f32 v17, v6, v13
  v_lshlrev_b32 v5, 16, v121
  v_and_b32 v6, 0xffff0000, v121
  v_fmac_f32 v18, v5, v13
  v_fmac_f32 v19, v6, v13
  v_lshlrev_b32 v5, 16, v122
  v_and_b32 v6, 0xffff0000, v122
  v_fmac_f32 v20, v5, v13
  v_fmac_f32 v21, v6, v13
  v_lshlrev_b32 v5, 16, v123
  v_and_b32 v6, 0xffff0000, v123
  v_fmac_f32 v22, v5, v13
  v_fmac_f32 v23, v6, v13
  v_lshlrev_b32 v6, 5, v0
  v_cmp_gt_u32 vcc, 216, v0
  s_and_saveexec_b64 s[50:51], vcc
  ds_write_b128 v6, v[16:19] offset:9216
  ds_write_b128 v6, v[20:23] offset:9232
  s_mov_b64 exec, -1
  s_waitcnt lgkmcnt(0)
  v_mov_b32 v58, 18708
  v_mov_b32 v59, 1
  s_mov_b64 exec, 1
  ds_add_u32 v58, v59
  s_mov_b64 exec, -1
  v_mov_b32 v58, 18708
  s_mov_b32 s91, 0
LW_27:
  ds_read_b32 v59, v58
  s_waitcnt lgkmcnt(0)
  v_readfirstlane_b32 s90, v59
  s_nop 3
  s_cmp_ge_u32 s90, 4
  s_cbranch_scc1 LD_28
  s_add_u32 s91, s91, 1
  s_cmp_gt_u32 s91, 1000000
  s_cbranch_scc1 LD_28
  s_sleep 1
  s_branch LW_27
LD_28:
  v_lshlrev_b32 v6, 2, v0
  v_and_b32 v5, 63, v0
  v_lshlrev_b32 v5, 2, v5
  ds_read_b32 v16, v6 offset:9216
  ds_read_b32 v17, v6 offset:11520
  ds_read_b32 v18, v6 offset:13824
  ds_read_b32 v19, v6 offset:10240
  ds_read_b32 v20, v6 offset:12544
  ds_read_b32 v21, v6 offset:14848
  ds_read_b32 v22, v5 offset:11264
  ds_read_b32 v23, v5 offset:13568
  ds_read_b32 v24, v5 offset:15872
  s_waitcnt lgkmcnt(0)
  v_add_f32 v16, v16, v17
  v_add_f32 v48, v16, v18
  v_add_f32 v19, v19, v20
  v_add_f32 v49, v19, v21
  v_add_f32 v22, v22, v23
  v_add_f32 v50, v22, v24
  s_cmp_eq_u32 s3, 0
  s_cbranch_scc0 G_NOO
  s_lshr_b32 s45, s2, 3
  s_and_b32 s46, s2, 7
  v_and_b32 v4, 15, v1
  v_lshlrev_b32 v5, 4, v4
  s_lshl_b32 s47, s45, 8
  s_add_u32 s47, s47, 655360
  v_lshlrev_b32 v20, 10, v4
  v_lshrrev_b32 v6, 4, v1
  v_lshl_add_u32 v20, v6, 5, v20
  s_lshl_b32 s48, s45, 14
  s_lshl_b32 s49, s46, 7
  s_add_u32 s48, s48, s49
  s_add_u32 s48, s48, 131072
  s_waitcnt vmcnt(0)
  s_mov_b32 s91, 0
PL_29:
  buffer_load_dwordx4 v[8:11], v5, s[80:83], s47 offen sc0 sc1
  buffer_load_dwordx4 v[12:15], v20, s[80:83], s48 offen sc0 sc1
  buffer_load_dwordx4 v[16:19], v20, s[80:83], s48 offen offset:16 sc0 sc1
  s_waitcnt vmcnt(0)
  v_cmp_ne_u32 vcc, s95, v9
  v_cmp_ne_u32 s[50:51], s95, v11
  s_or_b64 vcc, vcc, s[50:51]
  v_cmp_ne_u32 s[50:51], s95, v13
  s_or_b64 vcc, vcc, s[50:51]
  v_cmp_ne_u32 s[50:51], s95, v15
  s_or_b64 vcc, vcc, s[50:51]
  v_cmp_ne_u32 s[50:51], s95, v17
  s_or_b64 vcc, vcc, s[50:51]
  v_cmp_ne_u32 s[50:51], s95, v19
  s_or_b64 vcc, vcc, s[50:51]
  s_cbranch_scc0 PD_30
  s_add_u32 s91, s91, 1
  s_cmp_gt_u32 s91, 20000
  s_cbranch_scc1 PD_30
  s_sleep 2
  s_branch PL_29
PD_30:
  v_mov_b32 v9, v10
  v_mov_b32 v13, v14
  v_mov_b32 v14, v16
  v_mov_b32 v15, v18
  v_mov_b32 v10, v8
  s_nop 1
  v_max_f32_dpp v10, v10, v10 row_ror:8 row_mask:0xf bank_mask:0xf
  s_nop 1
  v_max_f32_dpp v10, v10, v10 row_ror:4 row_mask:0xf bank_mask:0xf
  s_nop 1
  v_max_f32_dpp v10, v10, v10 row_ror:2 row_mask:0xf bank_mask:0xf
  s_nop 1
  v_max_f32_dpp v10, v10, v10 row_ror:1 row_mask:0xf bank_mask:0xf
  v_sub_f32 v8, v8, v10
  v_exp_f32 v8, v8
  s_nop 0
  v_mul_f32 v9, v9, v8
  v_mul_f32 v12, v12, v8
  v_mul_f32 v13, v13, v8
  v_mul_f32 v14, v14, v8
  v_mul_f32 v15, v15, v8
  s_nop 1
  v_add_f32_dpp v9, v9, v9 row_ror:8 row_mask:0xf bank_mask:0xf
  v_add_f32_dpp v12, v12, v12 row_ror:8 row_mask:0xf bank_mask:0xf
  v_add_f32_dpp v13, v13, v13 row_ror:8 row_mask:0xf bank_mask:0xf
  v_add_f32_dpp v14, v14, v14 row_ror:8 row_mask:0xf bank_mask:0xf
  v_add_f32_dpp v15, v15, v15 row_ror:8 row_mask:0xf bank_mask:0xf
  s_nop 1
  v_add_f32_dpp v9, v9, v9 row_ror:4 row_mask:0xf bank_mask:0xf
  v_add_f32_dpp v12, v12, v12 row_ror:4 row_mask:0xf bank_mask:0xf
  v_add_f32_dpp v13, v13, v13 row_ror:4 row_mask:0xf bank_mask:0xf
  v_add_f32_dpp v14, v14, v14 row_ror:4 row_mask:0xf bank_mask:0xf
  v_add_f32_dpp v15, v15, v15 row_ror:4 row_mask:0xf bank_mask:0xf
  s_nop 1
  v_add_f32_dpp v9, v9, v9 row_ror:2 row_mask:0xf bank_mask:0xf
  v_add_f32_dpp v12, v12, v12 row_ror:2 row_mask:0xf bank_mask:0xf
  v_add_f32_dpp v13, v13, v13 row_ror:2 row_mask:0xf bank_mask:0xf
  v_add_f32_dpp v14, v14, v14 row_ror:2 row_mask:0xf bank_mask:0xf
  v_add_f32_dpp v15, v15, v15 row_ror:2 row_mask:0xf bank_mask:0xf
  s_nop 1
  v_add_f32_dpp v9, v9, v9 row_ror:1 row_mask:0xf bank_mask:0xf
  v_add_f32_dpp v12, v12, v12 row_ror:1 row_mask:0xf bank_mask:0xf
  v_add_f32_dpp v13, v13, v13 row_ror:1 row_mask:0xf bank_mask:0xf
  v_add_f32_dpp v14, v14, v14 row_ror:1 row_mask:0xf bank_mask:0xf
  v_add_f32_dpp v15, v15, v15 row_ror:1 row_mask:0xf bank_mask:0xf
  v_rcp_f32 v9, v9
  s_nop 0
  v_mul_f32 v12, v12, v9
  v_cvt_pk_bf16_f32 v12, v12, v12
  v_lshlrev_b32 v12, 16, v12
  v_mul_f32 v13, v13, v9
  v_cvt_pk_bf16_f32 v13, v13, v13
  v_lshlrev_b32 v13, 16, v13
  v_mul_f32 v14, v14, v9
  v_cvt_pk_bf16_f32 v14, v14, v14
  v_lshlrev_b32 v14, 16, v14
  v_mul_f32 v15, v15, v9
  v_cvt_pk_bf16_f32 v15, v15, v15
  v_lshlrev_b32 v15, 16, v15
  v_lshlrev_b32 v6, 4, v6
  ds_write_b128 v6, v[12:15] offset:18432
  s_waitcnt lgkmcnt(0)
  v_mov_b32 v58, 18704
  v_mov_b32 v59, 1
  s_mov_b64 exec, 1
  ds_add_u32 v58, v59
  s_mov_b64 exec, -1
G_NOO:
  v_mov_b32 v58, 18704
  s_mov_b32 s91, 0
LW_31:
  ds_read_b32 v59, v58
  s_waitcnt lgkmcnt(0)
  v_readfirstlane_b32 s90, v59
  s_nop 3
  s_cmp_ge_u32 s90, 1
  s_cbranch_scc1 LD_32
  s_add_u32 s91, s91, 1
  s_cmp_gt_u32 s91, 1000000
  s_cbranch_scc1 LD_32
  s_sleep 1
  s_branch LW_31
LD_32:
  s_waitcnt vmcnt(0)
  ds_read_b32 v8, v7 offset:18432
  ds_read_b32 v9, v7 offset:18444
  ds_read_b32 v10, v7 offset:18456
  ds_read_b32 v11, v7 offset:18468
  ds_read_b32 v12, v7 offset:18480
  ds_read_b32 v13, v7 offset:18492
  s_waitcnt lgkmcnt(0)
  v_lshlrev_b32 v5, 16, v64
  v_and_b32 v6, 0xffff0000, v64
  v_mul_f32 v16, v5, v8
  v_mul_f32 v17, v6, v8
  v_lshlrev_b32 v5, 16, v65
  v_and_b32 v6, 0xffff0000, v65
  v_mul_f32 v18, v5, v8
  v_mul_f32 v19, v6, v8
  v_lshlrev_b32 v5, 16, v66
  v_and_b32 v6, 0xffff0000, v66
  v_mul_f32 v20, v5, v8
  v_mul_f32 v21, v6, v8
  v_lshlrev_b32 v5, 16, v67
  v_and_b32 v6, 0xffff0000, v67
  v_mul_f32 v22, v5, v8
  v_mul_f32 v23, v6, v8
  v_lshlrev_b32 v5, 16, v68
  v_and_b32 v6, 0xffff0000, v68
  v_fmac_f32 v16, v5, v9
  v_fmac_f32 v17, v6, v9
  v_lshlrev_b32 v5, 16, v69
  v_and_b32 v6, 0xffff0000, v69
  v_fmac_f32 v18, v5, v9
  v_fmac_f32 v19, v6, v9
  v_lshlrev_b32 v5, 16, v70
  v_and_b32 v6, 0xffff0000, v70
  v_fmac_f32 v20, v5, v9
  v_fmac_f32 v21, v6, v9
  v_lshlrev_b32 v5, 16, v71
  v_and_b32 v6, 0xffff0000, v71
  v_fmac_f32 v22, v5, v9
  v_fmac_f32 v23, v6, v9
  v_lshlrev_b32 v5, 16, v72
  v_and_b32 v6, 0xffff0000, v72
  v_fmac_f32 v16, v5, v10
  v_fmac_f32 v17, v6, v10
  v_lshlrev_b32 v5, 16, v73
  v_and_b32 v6, 0xffff0000, v73
  v_fmac_f32 v18, v5, v10
  v_fmac_f32 v19, v6, v10
  v_lshlrev_b32 v5, 16, v74
  v_and_b32 v6, 0xffff0000, v74
  v_fmac_f32 v20, v5, v10
  v_fmac_f32 v21, v6, v10
  v_lshlrev_b32 v5, 16, v75
  v_and_b32 v6, 0xffff0000, v75
  v_fmac_f32 v22, v5, v10
  v_fmac_f32 v23, v6, v10
  v_lshlrev_b32 v5, 16, v76
  v_and_b32 v6, 0xffff0000, v76
  v_fmac_f32 v16, v5, v11
  v_fmac_f32 v17, v6, v11
  v_lshlrev_b32 v5, 16, v77
  v_and_b32 v6, 0xffff0000, v77
  v_fmac_f32 v18, v5, v11
  v_fmac_f32 v19, v6, v11
  v_lshlrev_b32 v5, 16, v78
  v_and_b32 v6, 0xffff0000, v78
  v_fmac_f32 v20, v5, v11
  v_fmac_f32 v21, v6, v11
  v_lshlrev_b32 v5, 16, v79
  v_and_b32 v6, 0xffff0000, v79
  v_fmac_f32 v22, v5, v11
  v_fmac_f32 v23, v6, v11
  v_lshlrev_b32 v5, 16, v80
  v_and_b32 v6, 0xffff0000, v80
  v_fmac_f32 v16, v5, v12
  v_fmac_f32 v17, v6, v12
  v_lshlrev_b32 v5, 16, v81
  v_and_b32 v6, 0xffff0000, v81
  v_fmac_f32 v18, v5, v12
  v_fmac_f32 v19, v6, v12
  v_lshlrev_b32 v5, 16, v82
  v_and_b32 v6, 0xffff0000, v82
  v_fmac_f32 v20, v5, v12
  v_fmac_f32 v21, v6, v12
  v_lshlrev_b32 v5, 16, v83
  v_and_b32 v6, 0xffff0000, v83
  v_fmac_f32 v22, v5, v12
  v_fmac_f32 v23, v6, v12
  v_lshlrev_b32 v5, 16, v84
  v_and_b32 v6, 0xffff0000, v84
  v_fmac_f32 v16, v5, v13
  v_fmac_f32 v17, v6, v13
  v_lshlrev_b32 v5, 16, v85
  v_and_b32 v6, 0xffff0000, v85
  v_fmac_f32 v18, v5, v13
  v_fmac_f32 v19, v6, v13
  v_lshlrev_b32 v5, 16, v86
  v_and_b32 v6, 0xffff0000, v86
  v_fmac_f32 v20, v5, v13
  v_fmac_f32 v21, v6, v13
  v_lshlrev_b32 v5, 16, v87
  v_and_b32 v6, 0xffff0000, v87
  v_fmac_f32 v22, v5, v13
  v_fmac_f32 v23, v6, v13
  v_lshlrev_b32 v6, 5, v0
  v_cmp_gt_u32 vcc, 216, v0
  s_and_saveexec_b64 s[50:51], vcc
  ds_write_b128 v6, v[16:19] offset:35392
  ds_write_b128 v6, v[20:23] offset:35408
  s_mov_b64 exec, -1
  s_waitcnt lgkmcnt(0)
  v_mov_b32 v58, 18712
  v_mov_b32 v59, 1
  s_mov_b64 exec, 1
  ds_add_u32 v58, v59
  s_mov_b64 exec, -1
  v_mov_b32 v58, 18712
  s_mov_b32 s91, 0
LW_33:
  ds_read_b32 v59, v58
  s_waitcnt lgkmcnt(0)
  v_readfirstlane_b32 s90, v59
  s_nop 3
  s_cmp_ge_u32 s90, 4
  s_cbranch_scc1 LD_34
  s_add_u32 s91, s91, 1
  s_cmp_gt_u32 s91, 1000000
  s_cbranch_scc1 LD_34
  s_sleep 1
  s_branch LW_33
LD_34:
  v_lshlrev_b32 v6, 2, v0
  v_and_b32 v5, 63, v0
  v_lshlrev_b32 v5, 2, v5
  ds_read_b32 v16, v6 offset:35392
  ds_read_b32 v17, v6 offset:37696
  ds_read_b32 v18, v6 offset:40000
  ds_read_b32 v19, v6 offset:36416
  ds_read_b32 v20, v6 offset:38720
  ds_read_b32 v21, v6 offset:41024
  ds_read_b32 v22, v5 offset:37440
  ds_read_b32 v23, v5 offset:39744
  ds_read_b32 v24, v5 offset:42048
  s_waitcnt lgkmcnt(0)
  v_add_f32 v16, v16, v17
  v_add_f32 v16, v16, v18
  v_add_f32 v48, v48, v16
  v_add_f32 v19, v19, v20
  v_add_f32 v19, v19, v21
  v_add_f32 v49, v49, v19
  v_add_f32 v22, v22, v23
  v_add_f32 v22, v22, v24
  v_add_f32 v50, v50, v22
  s_mul_i32 s52, s4, 2304
  s_add_u32 s52, s52, 663552
  buffer_atomic_add_f32 v48, v6, s[80:83], s52 offen sc1
  buffer_atomic_add_f32 v49, v6, s[80:83], s52 offen offset:1024 sc1
  v_cmp_gt_u32 vcc, 64, v0
  s_and_saveexec_b64 s[50:51], vcc
  s_cbranch_execz G_NOAT
  buffer_atomic_add_f32 v50, v6, s[80:83], s52 offen offset:2048 sc1
G_NOAT:
  s_mov_b64 exec, -1
  s_waitcnt vmcnt(0)
  s_waitcnt lgkmcnt(0)
  v_mov_b32 v58, 18716
  v_mov_b32 v59, 1
  s_mov_b64 exec, 1
  ds_add_u32 v58, v59
  s_mov_b64 exec, -1
  s_cmp_eq_u32 s3, 0
  s_cbranch_scc0 G_WL
  v_mov_b32 v58, 18716
  s_mov_b32 s91, 0
LW_35:
  ds_read_b32 v59, v58
  s_waitcnt lgkmcnt(0)
  v_readfirstlane_b32 s90, v59
  s_nop 3
  s_cmp_ge_u32 s90, 4
  s_cbranch_scc1 LD_36
  s_add_u32 s91, s91, 1
  s_cmp_gt_u32 s91, 1000000
  s_cbranch_scc1 LD_36
  s_sleep 1
  s_branch LW_35
LD_36:
  s_lshl_b32 s44, s4, 8
  s_add_u32 s44, s44, 700416
  v_mov_b32 v4, 0
  v_mov_b32 v5, 1
  s_mov_b64 exec, 1
  buffer_atomic_add v5, v4, s[80:83], s44 offen sc0 sc1
  s_waitcnt vmcnt(0)
  v_readfirstlane_b32 s45, v5
  s_nop 3
  s_mov_b32 s46, 1
  s_cmp_eq_u32 s45, 15
  s_cbranch_scc0 G_NL
  v_mov_b32 v5, 1
  buffer_atomic_add v5, v4, s[84:87], 0 offen offset:192 sc0 sc1
  s_waitcnt vmcnt(0)
  v_readfirstlane_b32 s45, v5
  s_nop 3
  s_cmp_eq_u32 s45, 15
  s_cbranch_scc0 G_NL
  s_mov_b32 s46, 2
G_NL:
  v_mov_b32 v4, 18720
  v_mov_b32 v5, s46
  ds_write_b32 v4, v5
  s_mov_b64 exec, -1
G_WL:
  v_mov_b32 v58, 18720
  s_mov_b32 s91, 0
LW_37:
  ds_read_b32 v59, v58
  s_waitcnt lgkmcnt(0)
  v_readfirstlane_b32 s90, v59
  s_nop 3
  s_cmp_ge_u32 s90, 1
  s_cbranch_scc1 LD_38
  s_add_u32 s91, s91, 1
  s_cmp_gt_u32 s91, 1000000
  s_cbranch_scc1 LD_38
  s_sleep 1
  s_branch LW_37
LD_38:
  s_cmp_eq_u32 s90, 2
  s_cbranch_scc0 K_END
  s_mov_b32 s32, s8
  s_mov_b32 s33, s9
  s_mov_b32 s34, 1152
  s_mov_b32 s35, 0x00020000
  s_mov_b32 s36, s26
  s_mov_b32 s37, s27
  s_mov_b32 s38, 1152
  s_mov_b32 s39, 0x00020000
  v_lshlrev_b32 v6, 2, v0
  v_lshlrev_b32 v5, 1, v0
  v_and_b32 v7, 63, v0
  v_lshlrev_b32 v9, 2, v7
  v_lshlrev_b32 v7, 1, v7
  s_mov_b32 s44, 663552
  buffer_load_dword v100, v6, s[80:83], s44 offen sc0 sc1
  s_add_u32 s44, s44, 2304
  buffer_load_dword v101, v6, s[80:83], s44 offen sc0 sc1
  s_add_u32 s44, s44, 2304
  buffer_load_dword v102, v6, s[80:83], s44 offen sc0 sc1
  s_add_u32 s44, s44, 2304
  buffer_load_dword v103, v6, s[80:83], s44 offen sc0 sc1
  s_add_u32 s44, s44, 2304
  buffer_load_dword v104, v6, s[80:83], s44 offen sc0 sc1
  s_add_u32 s44, s44, 2304
  buffer_load_dword v105, v6, s[80:83], s44 offen sc0 sc1
  s_add_u32 s44, s44, 2304
  buffer_load_dword v106, v6, s[80:83], s44 offen sc0 sc1
  s_add_u32 s44, s44, 2304
  buffer_load_dword v107, v6, s[80:83], s44 offen sc0 sc1
  s_add_u32 s44, s44, 2304
  buffer_load_dword v108, v6, s[80:83], s44 offen sc0 sc1
  s_add_u32 s44, s44, 2304
  buffer_load_dword v109, v6, s[80:83], s44 offen sc0 sc1
  s_add_u32 s44, s44, 2304
  buffer_load_dword v110, v6, s[80:83], s44 offen sc0 sc1
  s_add_u32 s44, s44, 2304
  buffer_load_dword v111, v6, s[80:83], s44 offen sc0 sc1
  s_add_u32 s44, s44, 2304
  buffer_load_dword v112, v6, s[80:83], s44 offen sc0 sc1
  s_add_u32 s44, s44, 2304
  buffer_load_dword v113, v6, s[80:83], s44 offen sc0 sc1
  s_add_u32 s44, s44, 2304
  buffer_load_dword v114, v6, s[80:83], s44 offen sc0 sc1
  s_add_u32 s44, s44, 2304
  buffer_load_dword v115, v6, s[80:83], s44 offen sc0 sc1
  s_add_u32 s44, s44, 2304
  buffer_load_ushort v10, v5, s[32:35], 0 offen offset:0
  s_mov_b32 s44, 664576
  buffer_load_dword v116, v6, s[80:83], s44 offen sc0 sc1
  s_add_u32 s44, s44, 2304
  buffer_load_dword v117, v6, s[80:83], s44 offen sc0 sc1
  s_add_u32 s44, s44, 2304
  buffer_load_dword v118, v6, s[80:83], s44 offen sc0 sc1
  s_add_u32 s44, s44, 2304
  buffer_load_dword v119, v6, s[80:83], s44 offen sc0 sc1
  s_add_u32 s44, s44, 2304
  buffer_load_dword v120, v6, s[80:83], s44 offen sc0 sc1
  s_add_u32 s44, s44, 2304
  buffer_load_dword v121, v6, s[80:83], s44 offen sc0 sc1
  s_add_u32 s44, s44, 2304
  buffer_load_dword v122, v6, s[80:83], s44 offen sc0 sc1
  s_add_u32 s44, s44, 2304
  buffer_load_dword v123, v6, s[80:83], s44 offen sc0 sc1
  s_add_u32 s44, s44, 2304
  buffer_load_dword v124, v6, s[80:83], s44 offen sc0 sc1
  s_add_u32 s44, s44, 2304
  buffer_load_dword v125, v6, s[80:83], s44 offen sc0 sc1
  s_add_u32 s44, s44, 2304
  buffer_load_dword v126, v6, s[80:83], s44 offen sc0 sc1
  s_add_u32 s44, s44, 2304
  buffer_load_dword v127, v6, s[80:83], s44 offen sc0 sc1
  s_add_u32 s44, s44, 2304
  buffer_load_dword v128, v6, s[80:83], s44 offen sc0 sc1
  s_add_u32 s44, s44, 2304
  buffer_load_dword v129, v6, s[80:83], s44 offen sc0 sc1
  s_add_u32 s44, s44, 2304
  buffer_load_dword v130, v6, s[80:83], s44 offen sc0 sc1
  s_add_u32 s44, s44, 2304
  buffer_load_dword v131, v6, s[80:83], s44 offen sc0 sc1
  s_add_u32 s44, s44, 2304
  buffer_load_ushort v11, v5, s[32:35], 0 offen offset:512
  s_mov_b32 s44, 665600
  buffer_load_dword v132, v9, s[80:83], s44 offen sc0 sc1
  s_add_u32 s44, s44, 2304
  buffer_load_dword v133, v9, s[80:83], s44 offen sc0 sc1
  s_add_u32 s44, s44, 2304
  buffer_load_dword v134, v9, s[80:83], s44 offen sc0 sc1
  s_add_u32 s44, s44, 2304
  buffer_load_dword v135, v9, s[80:83], s44 offen sc0 sc1
  s_add_u32 s44, s44, 2304
  buffer_load_dword v136, v9, s[80:83], s44 offen sc0 sc1
  s_add_u32 s44, s44, 2304
  buffer_load_dword v137, v9, s[80:83], s44 offen sc0 sc1
  s_add_u32 s44, s44, 2304
  buffer_load_dword v138, v9, s[80:83], s44 offen sc0 sc1
  s_add_u32 s44, s44, 2304
  buffer_load_dword v139, v9, s[80:83], s44 offen sc0 sc1
  s_add_u32 s44, s44, 2304
  buffer_load_dword v140, v9, s[80:83], s44 offen sc0 sc1
  s_add_u32 s44, s44, 2304
  buffer_load_dword v141, v9, s[80:83], s44 offen sc0 sc1
  s_add_u32 s44, s44, 2304
  buffer_load_dword v142, v9, s[80:83], s44 offen sc0 sc1
  s_add_u32 s44, s44, 2304
  buffer_load_dword v143, v9, s[80:83], s44 offen sc0 sc1
  s_add_u32 s44, s44, 2304
  buffer_load_dword v144, v9, s[80:83], s44 offen sc0 sc1
  s_add_u32 s44, s44, 2304
  buffer_load_dword v145, v9, s[80:83], s44 offen sc0 sc1
  s_add_u32 s44, s44, 2304
  buffer_load_dword v146, v9, s[80:83], s44 offen sc0 sc1
  s_add_u32 s44, s44, 2304
  buffer_load_dword v147, v9, s[80:83], s44 offen sc0 sc1
  s_add_u32 s44, s44, 2304
  buffer_load_ushort v12, v7, s[32:35], 0 offen offset:1024
  s_waitcnt vmcnt(34)
  v_add_f32 v100, v100, v101
  v_add_f32 v100, v100, v102
  v_add_f32 v100, v100, v103
  v_add_f32 v100, v100, v104
  v_add_f32 v100, v100, v105
  v_add_f32 v100, v100, v106
  v_add_f32 v100, v100, v107
  v_add_f32 v100, v100, v108
  v_add_f32 v100, v100, v109
  v_add_f32 v100, v100, v110
  v_add_f32 v100, v100, v111
  v_add_f32 v100, v100, v112
  v_add_f32 v100, v100, v113
  v_add_f32 v100, v100, v114
  v_add_f32 v100, v100, v115
  v_lshlrev_b32 v8, 16, v10
  v_add_f32 v8, v8, v100
  v_cvt_pk_bf16_f32 v8, v8, v8
  buffer_store_short v8, v5, s[36:39], 0 offen offset:0
  s_waitcnt vmcnt(17)
  v_add_f32 v116, v116, v117
  v_add_f32 v116, v116, v118
  v_add_f32 v116, v116, v119
  v_add_f32 v116, v116, v120
  v_add_f32 v116, v116, v121
  v_add_f32 v116, v116, v122
  v_add_f32 v116, v116, v123
  v_add_f32 v116, v116, v124
  v_add_f32 v116, v116, v125
  v_add_f32 v116, v116, v126
  v_add_f32 v116, v116, v127
  v_add_f32 v116, v116, v128
  v_add_f32 v116, v116, v129
  v_add_f32 v116, v116, v130
  v_add_f32 v116, v116, v131
  v_lshlrev_b32 v8, 16, v11
  v_add_f32 v8, v8, v116
  v_cvt_pk_bf16_f32 v8, v8, v8
  buffer_store_short v8, v5, s[36:39], 0 offen offset:512
  s_waitcnt vmcnt(0)
  v_add_f32 v132, v132, v133
  v_add_f32 v132, v132, v134
  v_add_f32 v132, v132, v135
  v_add_f32 v132, v132, v136
  v_add_f32 v132, v132, v137
  v_add_f32 v132, v132, v138
  v_add_f32 v132, v132, v139
  v_add_f32 v132, v132, v140
  v_add_f32 v132, v132, v141
  v_add_f32 v132, v132, v142
  v_add_f32 v132, v132, v143
  v_add_f32 v132, v132, v144
  v_add_f32 v132, v132, v145
  v_add_f32 v132, v132, v146
  v_add_f32 v132, v132, v147
  v_lshlrev_b32 v8, 16, v12
  v_add_f32 v8, v8, v132
  v_cvt_pk_bf16_f32 v8, v8, v8
  v_cmp_gt_u32 vcc, 64, v0
  s_and_saveexec_b64 s[50:51], vcc
  s_cbranch_execz K_END
  buffer_store_short v8, v5, s[36:39], 0 offen offset:1024
K_END:
K_EXIT:
  s_endpgm
.section .rodata,"a"
.p2align 6
.amdhsa_kernel parallel_sum__sliding_block_cached__glu_gated_reglu__decode_kernel
  .amdhsa_next_free_vgpr 256
  .amdhsa_next_free_sgpr 100
  .amdhsa_accum_offset 256
  .amdhsa_group_segment_fixed_size 0
  .amdhsa_kernarg_size 96
  .amdhsa_user_sgpr_count 2
  .amdhsa_user_sgpr_kernarg_segment_ptr 1
  .amdhsa_system_sgpr_workgroup_id_x 1
.end_amdhsa_kernel
```
